```python
import torch

def _softmax(x, axis=-1):
    return torch.softmax(x, dim=axis)
def _gelu(x):
    return torch.nn.functional.gelu(x, approximate="tanh")
def _silu(x):
    return torch.nn.functional.silu(x)
def _sigmoid(x):
    return torch.sigmoid(x)
def _layernorm(x, axis=-1, eps=1e-5):
    m = x.mean(dim=axis, keepdim=True)
    v = x.var(dim=axis, keepdim=True, unbiased=False)
    return (x - m) / torch.sqrt(v + eps)
def _scatter_add(tgt, idx, src, axis=0):
    return tgt.clone().index_add_(axis, idx, src)
def _segment_sum(src, seg, n):
    out = torch.zeros((n,) + src.shape[1:], dtype=src.dtype)
    return out.index_add_(0, seg, src)
def _pad(x, pw):
    flat = tuple(v for pair in reversed(pw) for v in pair)
    return torch.nn.functional.pad(x, flat)

kernel_name = 'standalone__edge_featured_mpnn_gatedgcn__graph'

def setup_inputs():

    _w = (lambda a: (lambda t: t.to(torch.bfloat16) if t.is_floating_point() else t)(torch.as_tensor(a)))
    N, deg, D, De = 10000, 64, 64, max(4, 1)
    E = N * deg
    return {
        "x": _w((lambda *s: torch.randn(*s, dtype=torch.bfloat16) * 0.8)(N, D)),
        "e_attr": _w((lambda *s: torch.randn(*s, dtype=torch.bfloat16) * 0.8)(E, De)),
        "src": _w((lambda lo, hi, *s: torch.randint(lo, hi, s))(0, N, E).to(torch.int64)),
        "dst": _w((lambda lo, hi, *s: torch.randint(lo, hi, s))(0, N, E).to(torch.int64)),
        "w_a": _w((lambda *s: torch.randn(*s, dtype=torch.bfloat16) * 0.8)(D, D)),
        "w_b": _w((lambda *s: torch.randn(*s, dtype=torch.bfloat16) * 0.8)(D, D)),
        "w_c": _w((lambda *s: torch.randn(*s, dtype=torch.bfloat16) * 0.8)(De, D)),
        "w_u": _w((lambda *s: torch.randn(*s, dtype=torch.bfloat16) * 0.05)(D, D)),
        "w_v": _w((lambda *s: torch.randn(*s, dtype=torch.bfloat16) * 0.05)(D, D)),
    }

def reference(x, e_attr, src, dst, w_a, w_b, w_c, w_u, w_v):
    N, D = x.shape
    hv = x @ w_v
    g = x[dst] @ w_a + x[src] @ w_b + e_attr @ w_c
    eta = _sigmoid(g)
    denom = _segment_sum(eta, dst, N) + 1e-6
    eta_n = eta / denom[dst]
    agg = _segment_sum(eta_n * hv[src], dst, N)
    z = x @ w_u + agg
    relu_z = torch.where(z > 0, z, 0 * z)
    return x + relu_z
```

```asm
; @launch kernel=gcn_prep_kernel grid=(250,1,1) block=(1024,1,1) lds=66560
; @launch kernel=standalone__edge_featured_mpnn_gatedgcn__graph_kernel grid=(256,1,1) block=(1024,1,1) lds=150400
.amdgcn_target "amdgcn-amd-amdhsa--gfx950"
.text
.globl gcn_prep_kernel
.p2align 8
.type gcn_prep_kernel,@function
gcn_prep_kernel:
    s_cmp_ge_u32 s2, 250
    s_cbranch_scc1 K1_done
    s_load_dwordx16 s[4:19], s[0:1], 0
    s_load_dwordx8 s[20:27], s[0:1], 64
    v_readfirstlane_b32 s33, v0
    v_and_b32 v1, 63, v0
    v_lshlrev_b32 v3, 2, v0
    v_mov_b32 v20, 0
    v_mov_b32 v57, 1
    s_lshr_b32 s33, s33, 6
    s_cmp_ge_u32 s33, 10
    s_cbranch_scc1 K1_tables
    s_mul_i32 s28, s2, 10240
    v_lshl_add_u32 v58, v0, 4, s28
    s_lshl_b32 s29, s28, 1
    v_lshl_add_u32 v59, v0, 5, s29
    ds_write_b32 v3, v20 offset:30720
    s_waitcnt lgkmcnt(0)
    global_load_dwordx4 v[4:7], v58, s[10:11]
    global_load_dwordx4 v[8:11], v58, s[8:9]
    global_load_dwordx4 v[12:15], v59, s[6:7]
    global_load_dwordx4 v[16:19], v59, s[6:7] offset:16
    s_mov_b32 s30, 52429
    s_movk_i32 s31, -40
    s_barrier
    s_waitcnt vmcnt(3)
    v_mul_u32_u24 v20, s30, v4
    v_mul_u32_u24 v21, s30, v5
    v_mul_u32_u24 v22, s30, v6
    v_mul_u32_u24 v23, s30, v7
    v_lshrrev_b32 v20, 21, v20
    v_lshrrev_b32 v21, 21, v21
    v_lshrrev_b32 v22, 21, v22
    v_lshrrev_b32 v23, 21, v23
    v_mad_i32_i24 v28, v20, s31, v4
    v_mad_i32_i24 v29, v21, s31, v5
    v_mad_i32_i24 v30, v22, s31, v6
    v_mad_i32_i24 v31, v23, s31, v7
    v_lshlrev_b32 v20, 2, v20
    v_lshlrev_b32 v21, 2, v21
    v_lshlrev_b32 v22, 2, v22
    v_lshlrev_b32 v23, 2, v23
    ds_add_rtn_u32 v24, v20, v57 offset:30720
    ds_add_rtn_u32 v25, v21, v57 offset:30720
    ds_add_rtn_u32 v26, v22, v57 offset:30720
    ds_add_rtn_u32 v27, v23, v57 offset:30720
    v_lshlrev_b32 v32, 4, v1
    s_waitcnt lgkmcnt(0)
    s_barrier
    ds_read_b128 v[36:39], v32 offset:30720
    s_waitcnt vmcnt(2)
    v_lshlrev_b32 v8, 8, v8
    v_lshlrev_b32 v9, 8, v9
    v_lshlrev_b32 v10, 8, v10
    v_lshlrev_b32 v11, 8, v11
    v_lshl_or_b32 v28, v28, 26, v8
    v_lshl_or_b32 v29, v29, 26, v9
    v_lshl_or_b32 v30, v30, 26, v10
    v_lshl_or_b32 v31, v31, 26, v11
    s_waitcnt lgkmcnt(0)
    v_add_u32 v40, v36, v37
    v_add_u32 v41, v40, v38
    v_add_u32 v42, v41, v39
    v_mov_b32 v43, v42
    s_nop 1
    v_add_u32_dpp v43, v43, v43 row_shr:1 row_mask:0xf bank_mask:0xf
    s_nop 1
    v_add_u32_dpp v43, v43, v43 row_shr:2 row_mask:0xf bank_mask:0xf
    s_nop 1
    v_add_u32_dpp v43, v43, v43 row_shr:4 row_mask:0xf bank_mask:0xf
    s_nop 1
    v_add_u32_dpp v43, v43, v43 row_shr:8 row_mask:0xf bank_mask:0xf
    s_nop 1
    v_add_u32_dpp v43, v43, v43 row_bcast:15 row_mask:0xa bank_mask:0xf
    s_nop 1
    v_add_u32_dpp v43, v43, v43 row_bcast:31 row_mask:0xc bank_mask:0xf
    v_sub_u32 v44, v43, v42
    v_add_u32 v45, v44, v36
    v_add_u32 v46, v44, v40
    v_add_u32 v47, v44, v41
    ds_write_b128 v32, v[44:47] offset:33280
    ds_read_b32 v52, v20 offset:33280
    ds_read_b32 v53, v21 offset:33280
    ds_read_b32 v54, v22 offset:33280
    ds_read_b32 v55, v23 offset:33280
    s_cmp_lg_u32 s33, 0
    s_cbranch_scc1 K1_notab
    v_mul_u32_u24 v48, 12, v44
    v_mul_u32_u24 v49, 12, v45
    v_mul_u32_u24 v50, 12, v46
    v_mul_u32_u24 v51, 12, v47
    v_lshl_or_b32 v48, v36, 16, v48
    v_lshl_or_b32 v49, v37, 16, v49
    v_lshl_or_b32 v50, v38, 16, v50
    v_lshl_or_b32 v51, v39, 16, v51
    s_lshl_b32 s34, s2, 10
    v_add_u32 v33, s34, v32
    s_add_u32 s36, s26, 0x500000
    s_addc_u32 s37, s27, 0
    global_store_dwordx4 v33, v[48:51], s[36:37] sc1
    s_cmp_ge_u32 s2, 6
    s_cbranch_scc1 K1_notab
    v_mov_b32 v48, 0
    v_mov_b32 v49, 0
    v_mov_b32 v50, 0
    v_mov_b32 v51, 0
    v_add_u32 v33, 256000, v33
    global_store_dwordx4 v33, v[48:51], s[36:37] sc1
K1_notab:
    s_waitcnt lgkmcnt(0)
    v_add_u32 v52, v52, v24
    v_add_u32 v53, v53, v25
    v_add_u32 v54, v54, v26
    v_add_u32 v55, v55, v27
    v_mul_u32_u24 v52, 12, v52
    v_mul_u32_u24 v53, 12, v53
    v_mul_u32_u24 v54, 12, v54
    v_mul_u32_u24 v55, 12, v55
    s_cmp_lg_u32 s33, 0
    s_cbranch_scc1 K1_attr_all
    s_cmp_lt_u32 s2, 6
    s_cbranch_scc1 K1_attr_two
    s_waitcnt vmcnt(1)
    s_branch K1_attr_ready
K1_attr_two:
    s_waitcnt vmcnt(2)
    s_branch K1_attr_ready
K1_attr_all:
    s_waitcnt vmcnt(0)
K1_attr_ready:
    ds_write2_b32 v52, v12, v13 offset0:0 offset1:1
    ds_write_b32 v52, v28 offset:8
    ds_write2_b32 v53, v14, v15 offset0:0 offset1:1
    ds_write_b32 v53, v29 offset:8
    ds_write2_b32 v54, v16, v17 offset0:0 offset1:1
    ds_write_b32 v54, v30 offset:8
    ds_write2_b32 v55, v18, v19 offset0:0 offset1:1
    ds_write_b32 v55, v31 offset:8
    s_mul_i32 s34, s2, 30720
    s_add_u32 s38, s26, 0x580000
    s_addc_u32 s39, s27, 0
    s_add_u32 s38, s38, s34
    s_addc_u32 s39, s39, 0
    s_add_u32 s40, s38, 0x2800
    s_addc_u32 s41, s39, 0
    s_add_u32 s42, s38, 0x5000
    s_addc_u32 s43, s39, 0
    v_lshlrev_b32 v3, 4, v0
    s_waitcnt lgkmcnt(0)
    s_barrier
    ds_read_b128 v[4:7], v3
    ds_read_b128 v[8:11], v3 offset:10240
    ds_read_b128 v[12:15], v3 offset:20480
    s_waitcnt lgkmcnt(2)
    global_store_dwordx4 v3, v[4:7], s[38:39] sc1
    s_waitcnt lgkmcnt(1)
    global_store_dwordx4 v3, v[8:11], s[40:41] sc1
    s_waitcnt lgkmcnt(0)
    global_store_dwordx4 v3, v[12:15], s[42:43] sc1
    s_endpgm
K1_tables:
    s_setprio 3
    s_sub_u32 s34, s33, 10
    s_and_b32 s35, s34, 1
    s_mul_i32 s43, s34, 2304
    s_add_u32 s43, s43, 52736
    s_lshr_b32 s34, s34, 1
    s_mul_i32 s36, s2, 40
    s_lshl_b32 s37, s34, 4
    s_add_u32 s36, s36, s37
    v_and_b32 v2, 15, v1
    v_lshrrev_b32 v3, 4, v1
    v_add_u32 v60, s36, v2
    v_min_u32 v59, 9999, v60
    v_lshlrev_b32 v59, 7, v59
    v_lshl_add_u32 v59, v3, 4, v59
    s_sub_u32 s37, s33, 10
    s_cmp_ge_u32 s37, 3
    s_cselect_b32 s44, 1, 0
    s_mul_i32 s45, s44, 192
    s_add_u32 s45, s45, 640
    v_subrev_u32 v60, s45, v0
    v_lshlrev_b32 v61, 4, v60
    v_lshrrev_b32 v62, 3, v60
    v_mul_u32_u24 v62, 144, v62
    v_and_b32 v63, 7, v60
    v_lshl_add_u32 v62, v63, 4, v62
    s_mul_i32 s45, s44, 9216
    s_add_u32 s45, s45, 34304
    v_add_u32 v62, s45, v62
    s_mul_i32 s45, s44, 3
    s_sub_u32 s46, s37, s45
    s_waitcnt lgkmcnt(0)
    s_cmp_eq_u32 s44, 0
    s_cselect_b32 s44, s14, s20
    s_cselect_b32 s45, s15, s21
    global_load_dwordx4 v[20:23], v59, s[4:5]
    global_load_dwordx4 v[24:27], v59, s[4:5] offset:64
    global_load_dwordx4 v[40:43], v61, s[44:45]
    global_load_dwordx4 v[44:47], v61, s[44:45] offset:3072
    s_cmp_eq_u32 s46, 2
    s_cbranch_scc1 K1_w2
    v_add_u32 v61, 0x1800, v61
    global_load_dwordx4 v[48:51], v61, s[44:45]
K1_w2:
    s_sub_u32 s47, s33, 10
    s_xor_b32 s48, s2, 1
    s_or_b32 s48, s48, s47
    s_cmp_lg_u32 s48, 0
    s_cbranch_scc1 K1_no_wcl
    v_lshlrev_b32 v14, 1, v1
    global_load_ushort v10, v14, s[16:17] offset:0
    global_load_ushort v11, v14, s[16:17] offset:128
    global_load_ushort v12, v14, s[16:17] offset:256
    global_load_ushort v13, v14, s[16:17] offset:384
K1_no_wcl:
    s_barrier
    v_lshrrev_b32 v4, 2, v2
    v_lshl_add_u32 v4, v3, 3, v4
    v_mul_u32_u24 v4, 144, v4
    v_and_b32 v63, 3, v2
    v_lshl_add_u32 v4, v63, 3, v4
    s_lshl_b32 s37, s35, 6
    s_add_u32 s37, s37, 34304
    v_add_u32 v4, s37, v4
    v_mul_u32_u24 v5, 144, v2
    v_lshl_add_u32 v5, v3, 4, v5
    v_add_u32 v5, s43, v5
    v_lshrrev_b32 v8, 3, v1
    v_and_b32 v9, 7, v1
    v_mul_u32_u24 v6, 144, v8
    v_lshl_add_u32 v6, v9, 4, v6
    v_add_u32 v6, s43, v6
    v_add_u32 v7, s36, v8
    v_lshlrev_b32 v7, 8, v7
    v_lshl_add_u32 v7, v9, 4, v7
    s_lshl_b32 s37, s35, 7
    v_add_u32 v7, s37, v7
    s_mov_b32 s40, 0xbfb8aa3b
    s_brev_b32 s41, 1
    s_mov_b32 s42, 0x7fff0000
    s_waitcnt vmcnt(0)
    s_cmp_lg_u32 s48, 0
    s_cbranch_scc1 K1_no_wcp
    v_lshlrev_b32 v16, 3, v1
    s_add_u32 s50, s26, 0x540000
    s_addc_u32 s51, s27, 0
    v_lshlrev_b32 v10, 16, v10
    v_lshlrev_b32 v11, 16, v11
    v_lshlrev_b32 v12, 16, v12
    v_lshlrev_b32 v13, 16, v13
    v_mul_f32 v10, s40, v10
    v_mul_f32 v11, s40, v11
    v_mul_f32 v12, s40, v12
    v_mul_f32 v13, s40, v13
    v_cvt_pk_bf16_f32 v14, v10, v11
    v_cvt_pk_bf16_f32 v15, v12, v13
    global_store_dwordx2 v16, v[14:15], s[50:51] sc1
K1_no_wcp:
    ds_write_b128 v62, v[40:43]
    ds_write_b128 v62, v[44:47] offset:3456
    s_cmp_eq_u32 s46, 2
    s_cbranch_scc1 K1_w2w
    ds_write_b128 v62, v[48:51] offset:6912
K1_w2w:
    s_waitcnt lgkmcnt(0)
    s_barrier
    ds_read_b64_tr_b16 v[28:29], v4 offset:0
    ds_read_b64_tr_b16 v[30:31], v4 offset:576
    ds_read_b64_tr_b16 v[32:33], v4 offset:4608
    ds_read_b64_tr_b16 v[34:35], v4 offset:5184
    ds_read_b64_tr_b16 v[36:37], v4 offset:9216
    ds_read_b64_tr_b16 v[38:39], v4 offset:9792
    ds_read_b64_tr_b16 v[40:41], v4 offset:13824
    ds_read_b64_tr_b16 v[42:43], v4 offset:14400
    s_waitcnt lgkmcnt(0)
    ds_read_b64_tr_b16 v[44:45], v4 offset:32
    ds_read_b64_tr_b16 v[46:47], v4 offset:608
    ds_read_b64_tr_b16 v[48:49], v4 offset:4640
    ds_read_b64_tr_b16 v[50:51], v4 offset:5216
    ds_read_b64_tr_b16 v[52:53], v4 offset:9248
    ds_read_b64_tr_b16 v[54:55], v4 offset:9824
    ds_read_b64_tr_b16 v[56:57], v4 offset:13856
    ds_read_b64_tr_b16 v[58:59], v4 offset:14432
    v_mfma_f32_16x16x32_bf16 v[64:67], v[28:31], v[20:23], 0
    v_mfma_f32_16x16x32_bf16 v[68:71], v[36:39], v[20:23], 0
    v_mfma_f32_16x16x32_bf16 v[64:67], v[32:35], v[24:27], v[64:67]
    v_mfma_f32_16x16x32_bf16 v[68:71], v[40:43], v[24:27], v[68:71]
    s_waitcnt lgkmcnt(0)
    v_mfma_f32_16x16x32_bf16 v[72:75], v[44:47], v[20:23], 0
    v_mfma_f32_16x16x32_bf16 v[76:79], v[52:55], v[20:23], 0
    v_mfma_f32_16x16x32_bf16 v[72:75], v[48:51], v[24:27], v[72:75]
    v_mfma_f32_16x16x32_bf16 v[76:79], v[56:59], v[24:27], v[76:79]
    s_nop 7
    v_mul_f32 v64, s40, v64
    v_mul_f32 v65, s40, v65
    v_mul_f32 v66, s40, v66
    v_mul_f32 v67, s40, v67
    v_mul_f32 v72, s40, v72
    v_mul_f32 v73, s40, v73
    v_mul_f32 v74, s40, v74
    v_mul_f32 v75, s40, v75
    v_cvt_pk_bf16_f32 v44, v64, v65
    v_cvt_pk_bf16_f32 v45, v66, v67
    v_cvt_pk_bf16_f32 v46, v72, v73
    v_cvt_pk_bf16_f32 v47, v74, v75
    v_and_b32 v64, 0xffff, v44
    v_lshrrev_b32 v65, 16, v44
    v_and_b32 v66, 0xffff, v45
    v_lshrrev_b32 v67, 16, v45
    v_and_b32 v72, 0xffff, v46
    v_lshrrev_b32 v73, 16, v46
    v_and_b32 v74, 0xffff, v47
    v_lshrrev_b32 v75, 16, v47
    v_and_b32 v48, 0x7fffffff, v68
    v_and_b32 v49, 0x7fffffff, v69
    v_and_b32 v50, 0x7fffffff, v70
    v_and_b32 v51, 0x7fffffff, v71
    v_and_b32 v52, 0x7fffffff, v76
    v_and_b32 v53, 0x7fffffff, v77
    v_and_b32 v54, 0x7fffffff, v78
    v_and_b32 v55, 0x7fffffff, v79
    v_add_u32 v48, 0x8000, v48
    v_add_u32 v49, 0x8000, v49
    v_add_u32 v50, 0x8000, v50
    v_add_u32 v51, 0x8000, v51
    v_add_u32 v52, 0x8000, v52
    v_add_u32 v53, 0x8000, v53
    v_add_u32 v54, 0x8000, v54
    v_add_u32 v55, 0x8000, v55
    v_sub_u32_e64 v48, v48, v64 clamp
    v_sub_u32_e64 v49, v49, v65 clamp
    v_sub_u32_e64 v50, v50, v66 clamp
    v_sub_u32_e64 v51, v51, v67 clamp
    v_sub_u32_e64 v52, v52, v72 clamp
    v_sub_u32_e64 v53, v53, v73 clamp
    v_sub_u32_e64 v54, v54, v74 clamp
    v_sub_u32_e64 v55, v55, v75 clamp
    v_and_or_b32 v28, v68, s41, v64
    v_and_or_b32 v29, v69, s41, v65
    v_and_or_b32 v30, v70, s41, v66
    v_and_or_b32 v31, v71, s41, v67
    v_and_or_b32 v32, v76, s41, v72
    v_and_or_b32 v33, v77, s41, v73
    v_and_or_b32 v34, v78, s41, v74
    v_and_or_b32 v35, v79, s41, v75
    v_bfi_b32 v28, s42, v48, v28
    v_bfi_b32 v29, s42, v49, v29
    v_bfi_b32 v30, s42, v50, v30
    v_bfi_b32 v31, s42, v51, v31
    v_bfi_b32 v32, s42, v52, v32
    v_bfi_b32 v33, s42, v53, v33
    v_bfi_b32 v34, s42, v54, v34
    v_bfi_b32 v35, s42, v55, v35
    ds_write_b128 v5, v[28:31] offset:0
    ds_write_b128 v5, v[32:35] offset:64
    s_waitcnt lgkmcnt(0)
    ds_read_b128 v[36:39], v6
    ds_read_b128 v[40:43], v6 offset:1152
    s_waitcnt lgkmcnt(1)
    global_store_dwordx4 v7, v[36:39], s[26:27] sc1
    s_cmp_eq_u32 s34, 2
    s_cbranch_scc1 K1_nost
    s_waitcnt lgkmcnt(0)
    global_store_dwordx4 v7, v[40:43], s[26:27] offset:2048 sc1
K1_nost:
    s_barrier
    s_cmp_lg_u32 s33, 10
    s_cbranch_scc1 K1_done
    s_cmp_lg_u32 s2, 0
    s_cbranch_scc1 K1_done
    v_lshlrev_b32 v2, 2, v1
    v_add_u32 v2, 0x271000, v2
    v_mov_b32 v3, 0x7f00
    global_store_dword v2, v3, s[26:27] sc1
K1_done:
    s_endpgm
.globl standalone__edge_featured_mpnn_gatedgcn__graph_kernel
.p2align 8
.type standalone__edge_featured_mpnn_gatedgcn__graph_kernel,@function
standalone__edge_featured_mpnn_gatedgcn__graph_kernel:
    s_cmp_ge_u32 s2, 256
    s_cbranch_scc1 K2_done
    s_and_b32 s3, s2, 7
    s_lshl_b32 s3, s3, 5
    s_lshr_b32 s37, s2, 3
    s_add_u32 s37, s37, s3
    s_load_dwordx16 s[4:19], s[0:1], 0
    s_load_dwordx8 s[20:27], s[0:1], 64
    s_cmp_ge_u32 s37, 250
    s_cbranch_scc1 K2_idle
    v_readfirstlane_b32 s38, v0
    v_and_b32 v1, 63, v0
    v_lshlrev_b32 v2, 2, v1
    s_lshr_b32 s38, s38, 6
    s_and_b32 s76, s38, 3
    s_lshl_b32 s76, s76, 2
    s_lshr_b32 s41, s38, 2
    s_add_u32 s76, s76, s41
    v_lshrrev_b32 v64, 4, v1
    s_lshl_b32 s69, s38, 2
    v_add_u32 v64, s69, v64
    v_lshlrev_b32 v64, 2, v64
    s_lshl_b32 s41, s37, 2
    v_lshl_add_u32 v65, v64, 10, s41
    v_lshlrev_b32 v66, 1, v1
    s_waitcnt lgkmcnt(0)
    s_add_u32 s32, s26, 0x500000
    s_addc_u32 s33, s27, 0
    global_load_dword v8, v65, s[32:33] offset:0
    global_load_dword v9, v65, s[32:33] offset:1024
    global_load_dword v10, v65, s[32:33] offset:2048
    global_load_dword v11, v65, s[32:33] offset:3072
    s_barrier
    s_cmp_lt_u32 s38, 8
    s_cselect_b32 s42, s12, s18
    s_cselect_b32 s43, s13, s19
    v_and_b32 v67, 0x1ff, v0
    v_lshlrev_b32 v68, 4, v67
    global_load_dwordx4 v[68:71], v68, s[42:43]
    s_cmp_ge_u32 s38, 6
    s_cbranch_scc1 K2_no_xop
    s_lshr_b32 s41, s38, 1
    s_lshl_b32 s41, s41, 4
    s_mul_i32 s69, s37, 40
    s_add_u32 s41, s41, s69
    v_and_b32 v65, 15, v1
    v_add_u32 v65, s41, v65
    v_min_u32 v65, 9999, v65
    v_lshlrev_b32 v65, 7, v65
    v_lshrrev_b32 v67, 4, v1
    v_lshl_add_u32 v65, v67, 4, v65
    global_load_dwordx4 v[112:115], v65, s[4:5]
    global_load_dwordx4 v[116:119], v65, s[4:5] offset:64
K2_no_xop:
    s_add_u32 s42, s26, 0x540000
    s_addc_u32 s43, s27, 0
    v_lshlrev_b32 v65, 3, v1
    global_load_dwordx2 v[88:89], v65, s[42:43]
    s_add_u32 s34, s26, 0x580000
    s_addc_u32 s35, s27, 0
    s_mov_b32 s28, s26
    s_and_b32 s29, s27, 0xffff
    s_or_b32 s29, s29, 0x40000
    s_mov_b32 s30, 2560256
    s_mov_b32 s31, 0x00800000
    v_mov_b32 v76, 0
    v_mov_b32 v77, 0
    v_mov_b32 v78, 0
    v_mov_b32 v79, 0
    v_lshlrev_b32 v67, 4, v0
    ds_write_b128 v67, v[76:79]
    v_cmp_gt_u32 vcc, 816, v0
    s_mov_b64 exec, vcc
    ds_write_b128 v67, v[76:79] offset:16384
    s_mov_b64 exec, -1
    v_and_b32 v16, 31, v1
    v_lshrrev_b32 v17, 5, v1
    v_bfe_u32 v18, v16, 2, 1
    v_lshrrev_b32 v19, 3, v16
    v_and_b32 v16, 3, v16
    v_lshl_add_u32 v16, v19, 2, v16
    v_cmp_eq_u32 vcc, v17, v18
    v_mov_b32 v20, 0x80
    v_lshlrev_b32 v16, 3, v16
    v_cndmask_b32 v5, 0, v20, vcc
    v_add_u32 v16, 85120, v16
    v_mov_b32 v20, 29008
    v_cndmask_b32 v6, v20, v16, vcc
    v_and_b32 v21, 1, v19
    v_lshlrev_b32 v21, 4, v21
    v_mov_b32 v22, 0x3f80
    v_lshlrev_b32 v21, v21, v22
    v_cndmask_b32 v21, 0, v21, vcc
    v_cmp_gt_u32 vcc, 2, v19
    v_mov_b32 v93, 0
    s_nop 0
    v_cndmask_b32 v86, 0, v21, vcc
    v_sub_u32 v87, v21, v86
    v_cmp_gt_u32 vcc, 32, v1
    s_nop 0
    v_add_u32 v106, 39936, v2
    v_cndmask_b32 v92, 0, v22, vcc
    v_mov_b32 v23, 0x2000
    v_mov_b32 v95, 0
    v_cndmask_b32 v94, 0, v23, vcc
    v_bfe_u32 v16, v1, 2, 2
    v_lshrrev_b32 v17, 4, v1
    v_and_b32 v18, 3, v1
    v_cmp_eq_u32 vcc, v16, v17
    v_mov_b32 v19, 31
    s_mov_b32 s71, 0x05040100
    v_cndmask_b32 v18, v19, v18, vcc
    v_lshlrev_b32 v18, v18, 1
    v_bfe_u32 v80, v18, 0, 1
    v_bfe_u32 v81, v18, 1, 1
    v_bfe_u32 v82, v18, 2, 1
    v_bfe_u32 v83, v18, 3, 1
    v_mul_u32_u24 v80, v22, v80
    v_mul_u32_u24 v81, v22, v81
    v_mul_u32_u24 v82, v22, v82
    v_mul_u32_u24 v83, v22, v83
    s_mov_b32 s39, 0
    v_and_b32 v79, 0x1ff, v0
    v_lshrrev_b32 v104, 3, v79
    v_mul_u32_u24 v104, 144, v104
    v_and_b32 v79, 7, v79
    v_lshl_add_u32 v104, v79, 4, v104
    s_lshr_b32 s41, s38, 3
    s_mul_i32 s41, s41, 9216
    s_add_u32 s41, s41, 85120
    v_add_u32 v104, s41, v104
    v_and_b32 v78, 15, v1
    v_lshrrev_b32 v79, 4, v1
    v_lshrrev_b32 v105, 2, v78
    v_lshl_add_u32 v105, v79, 3, v105
    v_mul_u32_u24 v105, 144, v105
    v_and_b32 v77, 3, v78
    v_lshl_add_u32 v105, v77, 3, v105
    s_and_b32 s41, s38, 1
    s_lshl_b32 s69, s41, 6
    s_add_u32 s69, s69, 85120
    v_add_u32 v105, s69, v105
    s_lshr_b32 s69, s38, 1
    s_lshl_b32 s69, s69, 4
    v_lshlrev_b32 v107, 2, v79
    v_add_u32 v107, s69, v107
    v_cmp_gt_u32 s[78:79], 40, v107
    v_lshlrev_b32 v107, 8, v107
    v_lshl_add_u32 v107, v78, 2, v107
    s_lshl_b32 s41, s41, 7
    v_add_u32 v107, s41, v107
    v_lshrrev_b32 v78, 4, v1
    s_lshl_b32 s69, s38, 2
    v_add_u32 v78, s69, v78
    v_mul_u32_u24 v78, 10240, v78
    v_and_b32 v76, 15, v1
    v_add_u32 v76, s39, v76
    v_add_u32 v78, v78, v76
    v_mul_u32_u24 v100, 12, v78
    v_add_u32 v101, 30720, v100
    v_add_u32 v102, 30720, v101
    v_add_u32 v103, 30720, v102
    v_add_u32 v77, 17, v76
    v_lshlrev_b32 v77, 16, v77
    s_cmp_ge_u32 s38, 6
    s_cbranch_scc1 K2_wdesc1
    s_waitcnt vmcnt(4)
    s_branch K2_wdesc
K2_wdesc1:
    s_waitcnt vmcnt(2)
K2_wdesc:
K2_pass:
    v_cmp_lt_u32_sdwa s[44:45], v76, v8 src0_sel:DWORD src1_sel:WORD_1
    v_cmp_lt_u32_sdwa s[46:47], v76, v9 src0_sel:DWORD src1_sel:WORD_1
    v_cmp_lt_u32_sdwa s[48:49], v76, v10 src0_sel:DWORD src1_sel:WORD_1
    v_cmp_lt_u32_sdwa s[50:51], v76, v11 src0_sel:DWORD src1_sel:WORD_1
    v_add_u32_sdwa v64, v8, v100 dst_sel:DWORD dst_unused:UNUSED_PAD src0_sel:WORD_0 src1_sel:DWORD
    v_add_u32_sdwa v65, v9, v101 dst_sel:DWORD dst_unused:UNUSED_PAD src0_sel:WORD_0 src1_sel:DWORD
    v_add_u32_sdwa v66, v10, v102 dst_sel:DWORD dst_unused:UNUSED_PAD src0_sel:WORD_0 src1_sel:DWORD
    v_add_u32_sdwa v67, v11, v103 dst_sel:DWORD dst_unused:UNUSED_PAD src0_sel:WORD_0 src1_sel:DWORD
    s_mov_b64 exec, s[44:45]
    global_load_dwordx3 v[16:18], v64, s[34:35]
    s_mov_b64 exec, s[46:47]
    global_load_dwordx3 v[20:22], v65, s[34:35]
    s_mov_b64 exec, s[48:49]
    global_load_dwordx3 v[24:26], v66, s[34:35]
    s_mov_b64 exec, s[50:51]
    global_load_dwordx3 v[28:30], v67, s[34:35]
    s_mov_b64 exec, -1
    v_max3_u32 v7, v8, v9, v10
    v_max_u32 v7, v7, v11
    s_mov_b32 s67, 0
    v_cmp_ge_u32 vcc, v7, v77
    s_cbranch_vccz K2_no_second
    v_add_u32 v79, 16, v76
    v_cmp_lt_u32_sdwa s[52:53], v79, v8 src0_sel:DWORD src1_sel:WORD_1
    v_cmp_lt_u32_sdwa s[54:55], v79, v9 src0_sel:DWORD src1_sel:WORD_1
    v_cmp_lt_u32_sdwa s[56:57], v79, v10 src0_sel:DWORD src1_sel:WORD_1
    v_cmp_lt_u32_sdwa s[58:59], v79, v11 src0_sel:DWORD src1_sel:WORD_1
    s_mov_b32 s67, 1
    s_mov_b64 exec, s[52:53]
    global_load_dwordx3 v[32:34], v64, s[34:35] offset:192
    s_mov_b64 exec, s[54:55]
    global_load_dwordx3 v[36:38], v65, s[34:35] offset:192
    s_mov_b64 exec, s[56:57]
    global_load_dwordx3 v[40:42], v66, s[34:35] offset:192
    s_mov_b64 exec, s[58:59]
    global_load_dwordx3 v[44:46], v67, s[34:35] offset:192
    s_mov_b64 exec, -1
K2_no_second:
    s_cmp_lg_u32 s39, 0
    s_cbranch_scc1 K2_tables_done
    s_cmp_eq_u32 s67, 0
    s_cbranch_scc1 K2_ww4
    s_waitcnt vmcnt(9)
    s_branch K2_ww
K2_ww4:
    s_waitcnt vmcnt(5)
K2_ww:
    ds_write_b128 v104, v[68:71]
    v_mov_b32 v68, 0
    ds_write_b32 v2, v68 offset:50176
    s_waitcnt lgkmcnt(0)
    s_barrier
    v_cmp_le_u32 vcc, 0x210000, v7
    s_cbranch_vccz K2_nomax
    v_mov_b32 v79, 28928
    ds_max_u32 v79, v7
K2_nomax:
    s_cmp_ge_u32 s38, 6
    s_cbranch_scc1 K2_tables_done
    s_mov_b32 s69, 0xbfb8aa3b
    ds_read_b64_tr_b16 v[48:49], v105 offset:0
    ds_read_b64_tr_b16 v[50:51], v105 offset:576
    ds_read_b64_tr_b16 v[52:53], v105 offset:4608
    ds_read_b64_tr_b16 v[54:55], v105 offset:5184
    ds_read_b64_tr_b16 v[56:57], v105 offset:9216
    ds_read_b64_tr_b16 v[58:59], v105 offset:9792
    ds_read_b64_tr_b16 v[60:61], v105 offset:13824
    ds_read_b64_tr_b16 v[62:63], v105 offset:14400
    s_waitcnt lgkmcnt(0)
    v_mfma_f32_16x16x32_bf16 v[120:123], v[112:115], v[48:51], 0
    v_mfma_f32_16x16x32_bf16 v[124:127], v[112:115], v[56:59], 0
    v_mfma_f32_16x16x32_bf16 v[120:123], v[116:119], v[52:55], v[120:123]
    v_mfma_f32_16x16x32_bf16 v[124:127], v[116:119], v[60:63], v[124:127]
    s_nop 7
    v_mul_f32 v120, s69, v120
    v_mul_f32 v121, s69, v121
    v_mul_f32 v122, s69, v122
    v_mul_f32 v123, s69, v123
    v_cvt_pk_bf16_f32 v124, v120, v124
    v_cvt_pk_bf16_f32 v125, v121, v125
    v_cvt_pk_bf16_f32 v126, v122, v126
    v_cvt_pk_bf16_f32 v127, v123, v127
    v_cvt_pk_bf16_f32 v120, v120, v120
    v_cvt_pk_bf16_f32 v121, v121, v121
    v_cvt_pk_bf16_f32 v122, v122, v122
    v_cvt_pk_bf16_f32 v123, v123, v123
    s_mov_b64 exec, s[78:79]
    ds_write_b32 v107, v124 offset:29696
    ds_write_b32 v107, v120 offset:39936
    ds_write_b32 v107, v125 offset:29952
    ds_write_b32 v107, v121 offset:40192
    ds_write_b32 v107, v126 offset:30208
    ds_write_b32 v107, v122 offset:40448
    ds_write_b32 v107, v127 offset:30464
    ds_write_b32 v107, v123 offset:40704
    s_mov_b64 exec, -1
    ds_read_b64_tr_b16 v[48:49], v105 offset:32
    ds_read_b64_tr_b16 v[50:51], v105 offset:608
    ds_read_b64_tr_b16 v[52:53], v105 offset:4640
    ds_read_b64_tr_b16 v[54:55], v105 offset:5216
    ds_read_b64_tr_b16 v[56:57], v105 offset:9248
    ds_read_b64_tr_b16 v[58:59], v105 offset:9824
    ds_read_b64_tr_b16 v[60:61], v105 offset:13856
    ds_read_b64_tr_b16 v[62:63], v105 offset:14432
    s_waitcnt lgkmcnt(0)
    v_mfma_f32_16x16x32_bf16 v[120:123], v[112:115], v[48:51], 0
    v_mfma_f32_16x16x32_bf16 v[124:127], v[112:115], v[56:59], 0
    v_mfma_f32_16x16x32_bf16 v[120:123], v[116:119], v[52:55], v[120:123]
    v_mfma_f32_16x16x32_bf16 v[124:127], v[116:119], v[60:63], v[124:127]
    s_nop 7
    v_mul_f32 v120, s69, v120
    v_mul_f32 v121, s69, v121
    v_mul_f32 v122, s69, v122
    v_mul_f32 v123, s69, v123
    v_cvt_pk_bf16_f32 v124, v120, v124
    v_cvt_pk_bf16_f32 v125, v121, v125
    v_cvt_pk_bf16_f32 v126, v122, v126
    v_cvt_pk_bf16_f32 v127, v123, v127
    v_cvt_pk_bf16_f32 v120, v120, v120
    v_cvt_pk_bf16_f32 v121, v121, v121
    v_cvt_pk_bf16_f32 v122, v122, v122
    v_cvt_pk_bf16_f32 v123, v123, v123
    s_mov_b64 exec, s[78:79]
    ds_write_b32 v107, v124 offset:29760
    ds_write_b32 v107, v120 offset:40000
    ds_write_b32 v107, v125 offset:30016
    ds_write_b32 v107, v121 offset:40256
    ds_write_b32 v107, v126 offset:30272
    ds_write_b32 v107, v122 offset:40512
    ds_write_b32 v107, v127 offset:30528
    ds_write_b32 v107, v123 offset:40768
    s_mov_b64 exec, -1
K2_tables_done:
    v_mov_b32 v112, 0xc27c0000
    v_mov_b32 v113, 0xc27c0000
    v_mov_b32 v114, 0xc27c0000
    v_mov_b32 v115, 0xc27c0000
    v_mov_b32 v116, 0xc27c0000
    v_mov_b32 v117, 0xc27c0000
    v_mov_b32 v118, 0xc27c0000
    v_mov_b32 v119, 0xc27c0000
    v_mov_b32 v120, 0xc27c0000
    v_mov_b32 v121, 0xc27c0000
    v_mov_b32 v122, 0xc27c0000
    v_mov_b32 v123, 0xc27c0000
    v_mov_b32 v124, 0xc27c0000
    v_mov_b32 v125, 0xc27c0000
    v_mov_b32 v126, 0xc27c0000
    v_mov_b32 v127, 0xc27c0000
    v_mov_b32 v78, 4
    s_waitcnt vmcnt(0)
    s_mov_b64 exec, s[44:45]
    v_lshrrev_b32 v64, 24, v18
    ds_add_rtn_u32 v19, v64, v78 offset:28672
    s_mov_b64 exec, s[46:47]
    v_lshrrev_b32 v65, 24, v22
    ds_add_rtn_u32 v23, v65, v78 offset:28672
    s_mov_b64 exec, s[48:49]
    v_lshrrev_b32 v66, 24, v26
    ds_add_rtn_u32 v27, v66, v78 offset:28672
    s_mov_b64 exec, s[50:51]
    v_lshrrev_b32 v67, 24, v30
    ds_add_rtn_u32 v31, v67, v78 offset:28672
    s_mov_b64 exec, -1
    s_cmp_eq_u32 s67, 0
    s_cbranch_scc1 K2_cnt_skip
    s_mov_b64 exec, s[52:53]
    v_lshrrev_b32 v68, 24, v34
    ds_add_rtn_u32 v35, v68, v78 offset:28672
    s_mov_b64 exec, s[54:55]
    v_lshrrev_b32 v69, 24, v38
    ds_add_rtn_u32 v39, v69, v78 offset:28672
    s_mov_b64 exec, s[56:57]
    v_lshrrev_b32 v70, 24, v42
    ds_add_rtn_u32 v43, v70, v78 offset:28672
    s_mov_b64 exec, s[58:59]
    v_lshrrev_b32 v71, 24, v46
    ds_add_rtn_u32 v47, v71, v78 offset:28672
    s_mov_b64 exec, -1
K2_cnt_skip:
    s_waitcnt lgkmcnt(0)
    s_barrier
    ds_read_b32 v76, v2 offset:28672
    v_mov_b32 v79, 28928
    ds_read_b32 v79, v79
    s_cmp_lg_u32 s39, 0
    s_cbranch_scc1 K2_late_loaded
    s_lshr_b32 s41, s2, 3
    s_mul_i32 s41, s41, 81920
    s_mul_i32 s69, s38, 2048
    s_add_u32 s41, s41, s69
    v_lshl_add_u32 v109, v1, 6, s41
    s_mov_b32 exec_lo, 0xffffffff
    s_mov_b32 exec_hi, 0x0
    global_load_dword v108, v109, s[26:27]
    s_mov_b64 exec, -1
K2_late_loaded:
    s_waitcnt lgkmcnt(0)
    v_readfirstlane_b32 s40, v79
    v_add_u32 v77, 12, v76
    v_and_b32 v77, -16, v77
    v_mov_b32 v14, v77
    s_lshr_b32 s40, s40, 16
    s_nop 1
    v_add_u32_dpp v14, v14, v14 row_shr:1 row_mask:0xf bank_mask:0xf
    s_nop 1
    v_add_u32_dpp v14, v14, v14 row_shr:2 row_mask:0xf bank_mask:0xf
    s_nop 1
    v_add_u32_dpp v14, v14, v14 row_shr:4 row_mask:0xf bank_mask:0xf
    s_nop 1
    v_add_u32_dpp v14, v14, v14 row_shr:8 row_mask:0xf bank_mask:0xf
    s_nop 1
    v_add_u32_dpp v14, v14, v14 row_bcast:15 row_mask:0xa bank_mask:0xf
    s_nop 1
    v_add_u32_dpp v14, v14, v14 row_bcast:31 row_mask:0xc bank_mask:0xf
    v_sub_u32 v75, v14, v77
    ds_write_b32 v2, v75 offset:29440
    s_mov_b64 exec, s[44:45]
    ds_read_b32 v48, v64 offset:29440
    s_mov_b64 exec, s[46:47]
    ds_read_b32 v49, v65 offset:29440
    s_mov_b64 exec, s[48:49]
    ds_read_b32 v50, v66 offset:29440
    s_mov_b64 exec, s[50:51]
    ds_read_b32 v51, v67 offset:29440
    s_mov_b64 exec, -1
    s_cmp_eq_u32 s67, 0
    s_cbranch_scc1 K2_st_skip
    s_mov_b64 exec, s[52:53]
    ds_read_b32 v52, v68 offset:29440
    s_mov_b64 exec, s[54:55]
    ds_read_b32 v53, v69 offset:29440
    s_mov_b64 exec, s[56:57]
    ds_read_b32 v54, v70 offset:29440
    s_mov_b64 exec, s[58:59]
    ds_read_b32 v55, v71 offset:29440
    s_mov_b64 exec, -1
K2_st_skip:
    v_readlane_b32 s61, v14, 63
    s_cmp_lt_u32 s38, 12
    s_cbranch_scc1 K2_nopad
    v_mov_b32 v74, 0x271000
    v_mov_b32 v72, 0
    v_mov_b32 v73, 0
    s_cmp_eq_u32 s38, 15
    s_cbranch_scc1 K2_tailpad
    s_sub_u32 s69, s38, 12
    s_lshl_b32 s69, s69, 2
    v_add_u32 v75, v75, v76
    v_add_u32 v75, s69, v75
    v_cmp_lt_u32 vcc, v75, v14
    s_mov_b32 s69, 85120
    v_lshl_add_u32 v78, v75, 1, s69
    s_mov_b64 exec, vcc
    ds_write_b32 v75, v74 offset:52480
    ds_write_b64 v78, v[72:73]
    s_mov_b64 exec, -1
    s_branch K2_nopad
K2_tailpad:
    s_add_u32 s69, s61, 63
    s_and_b32 s69, s69, -64
    v_add_u32 v75, s61, v2
    v_cmp_gt_u32 vcc, s69, v75
    s_mov_b32 s69, 85120
    v_lshl_add_u32 v78, v75, 1, s69
    v_lshrrev_b32 v77, 4, v75
    v_mov_b32 v76, 160
    s_mov_b64 exec, vcc
    ds_write_b32 v75, v74 offset:52480
    ds_write_b64 v78, v[72:73]
    ds_write_b8 v77, v76 offset:50432
    s_mov_b64 exec, -1
K2_nopad:
    s_waitcnt lgkmcnt(0)
    s_mov_b32 s70, 85120
    s_mov_b64 exec, s[44:45]
    v_add_u32 v48, v48, v19
    v_and_b32 v18, 0xffffff, v18
    v_lshl_add_u32 v19, v48, 1, s70
    ds_write_b32 v48, v18 offset:52480
    ds_write_b64 v19, v[16:17]
    v_lshrrev_b32 v48, 4, v48
    ds_write_b8 v48, v64 offset:50432
    s_mov_b64 exec, s[46:47]
    v_add_u32 v49, v49, v23
    v_and_b32 v22, 0xffffff, v22
    v_lshl_add_u32 v23, v49, 1, s70
    ds_write_b32 v49, v22 offset:52480
    ds_write_b64 v23, v[20:21]
    v_lshrrev_b32 v49, 4, v49
    ds_write_b8 v49, v65 offset:50432
    s_mov_b64 exec, s[48:49]
    v_add_u32 v50, v50, v27
    v_and_b32 v26, 0xffffff, v26
    v_lshl_add_u32 v27, v50, 1, s70
    ds_write_b32 v50, v26 offset:52480
    ds_write_b64 v27, v[24:25]
    v_lshrrev_b32 v50, 4, v50
    ds_write_b8 v50, v66 offset:50432
    s_mov_b64 exec, s[50:51]
    v_add_u32 v51, v51, v31
    v_and_b32 v30, 0xffffff, v30
    v_lshl_add_u32 v31, v51, 1, s70
    ds_write_b32 v51, v30 offset:52480
    ds_write_b64 v31, v[28:29]
    v_lshrrev_b32 v51, 4, v51
    ds_write_b8 v51, v67 offset:50432
    s_mov_b64 exec, -1
    s_cmp_eq_u32 s67, 0
    s_cbranch_scc1 K2_sc_skip
    s_mov_b64 exec, s[52:53]
    v_add_u32 v52, v52, v35
    v_and_b32 v34, 0xffffff, v34
    v_lshl_add_u32 v35, v52, 1, s70
    ds_write_b32 v52, v34 offset:52480
    ds_write_b64 v35, v[32:33]
    v_lshrrev_b32 v52, 4, v52
    ds_write_b8 v52, v68 offset:50432
    s_mov_b64 exec, s[54:55]
    v_add_u32 v53, v53, v39
    v_and_b32 v38, 0xffffff, v38
    v_lshl_add_u32 v39, v53, 1, s70
    ds_write_b32 v53, v38 offset:52480
    ds_write_b64 v39, v[36:37]
    v_lshrrev_b32 v53, 4, v53
    ds_write_b8 v53, v69 offset:50432
    s_mov_b64 exec, s[56:57]
    v_add_u32 v54, v54, v43
    v_and_b32 v42, 0xffffff, v42
    v_lshl_add_u32 v43, v54, 1, s70
    ds_write_b32 v54, v42 offset:52480
    ds_write_b64 v43, v[40:41]
    v_lshrrev_b32 v54, 4, v54
    ds_write_b8 v54, v70 offset:50432
    s_mov_b64 exec, s[58:59]
    v_add_u32 v55, v55, v47
    v_and_b32 v46, 0xffffff, v46
    v_lshl_add_u32 v47, v55, 1, s70
    ds_write_b32 v55, v46 offset:52480
    ds_write_b64 v47, v[44:45]
    v_lshrrev_b32 v55, 4, v55
    ds_write_b8 v55, v71 offset:50432
    s_mov_b64 exec, -1
K2_sc_skip:
K2_wc_done:
    s_add_u32 s69, s61, 63
    s_lshr_b32 s69, s69, 6
    s_mul_i32 s60, s69, s76
    s_add_u32 s61, s60, s69
    s_lshr_b32 s60, s60, 4
    s_lshr_b32 s61, s61, 4
    s_sub_u32 s61, s61, s60
    v_add_u32 v15, s60, v1
    v_lshlrev_b32 v15, 2, v15
    s_lshl_b32 s69, s60, 6
    v_mov_b32 v3, s69
    v_mad_u32_u24 v4, v5, s60, v6
    v_mul_u32_u24 v5, 3, v5
    v_mov_b32 v96, 0
    v_mov_b32 v97, 0
    v_mov_b32 v98, 0
    v_mov_b32 v99, 0
    s_cmp_eq_u32 s61, 0
    s_waitcnt lgkmcnt(0)
    s_barrier
    s_setprio 3
    s_cbranch_scc1 K2_empty_range
    ds_read_b128 v[16:19], v3 offset:52480
    ds_read_b128 v[20:23], v3 offset:52496
    ds_read_b128 v[24:27], v3 offset:52512
    ds_read_b128 v[28:31], v3 offset:52528
    ds_read_b128 v[32:35], v3 offset:52544
    ds_read_b128 v[36:39], v3 offset:52560
    ds_read_b128 v[40:43], v3 offset:52576
    ds_read_b128 v[44:47], v3 offset:52592
    ds_read_b32 v7, v15 offset:50432
    ds_read_b32 v104, v15 offset:50428
    ds_read_b64 v[84:85], v4 offset:0
    s_waitcnt lgkmcnt(7)
    buffer_load_dword v16, v16, s[28:31], 0 offen
    buffer_load_dword v17, v17, s[28:31], 0 offen
    buffer_load_dword v18, v18, s[28:31], 0 offen
    buffer_load_dword v19, v19, s[28:31], 0 offen
    buffer_load_dword v20, v20, s[28:31], 0 offen
    buffer_load_dword v21, v21, s[28:31], 0 offen
    buffer_load_dword v22, v22, s[28:31], 0 offen
    buffer_load_dword v23, v23, s[28:31], 0 offen
    buffer_load_dword v24, v24, s[28:31], 0 offen
    buffer_load_dword v25, v25, s[28:31], 0 offen
    buffer_load_dword v26, v26, s[28:31], 0 offen
    buffer_load_dword v27, v27, s[28:31], 0 offen
    buffer_load_dword v28, v28, s[28:31], 0 offen
    buffer_load_dword v29, v29, s[28:31], 0 offen
    buffer_load_dword v30, v30, s[28:31], 0 offen
    buffer_load_dword v31, v31, s[28:31], 0 offen
    s_waitcnt lgkmcnt(0)
    v_readlane_b32 s64, v7, 0
    s_bfe_u32 s69, s64, 0x80000
    s_lshl_b32 s69, s69, 6
    v_add_u32 v15, s69, v106
    ds_read_b32 v100, v15
    s_bfe_u32 s69, s64, 0x80008
    s_lshl_b32 s69, s69, 6
    v_add_u32 v15, s69, v106
    ds_read_b32 v101, v15
    s_bfe_u32 s69, s64, 0x80010
    s_lshl_b32 s69, s69, 6
    v_add_u32 v15, s69, v106
    ds_read_b32 v102, v15
    s_bfe_u32 s69, s64, 0x80018
    s_lshl_b32 s69, s69, 6
    v_add_u32 v15, s69, v106
    ds_read_b32 v103, v15
    s_mov_b32 s66, s64
    s_and_b32 s63, s64, 0xff
    s_lshl_b32 s68, s63, 6
    s_cmp_lg_u32 s39, 0
    s_cbranch_scc1 K2_carry_done
    v_readlane_b32 s70, v104, 0
    s_add_u32 s67, s76, 40
    s_lshl_b32 s67, s67, 8
    s_lshr_b32 s70, s70, 24
    s_cmp_eq_u32 s60, 0
    s_cselect_b32 s70, 0x100, s70
    s_cmp_eq_u32 s70, s63
    s_cselect_b32 s68, s67, s68
    s_cselect_b32 s70, s63, 0xff
    s_lshl_b32 s69, s76, 2
    v_mov_b32 v15, s69
    v_mov_b32 v104, s70
    ds_write_b32 v15, v104 offset:28944
K2_carry_done:
    s_mov_b32 s62, 0
    s_waitcnt lgkmcnt(0)
    v_perm_b32 v90, v101, v100, s71
    v_perm_b32 v91, v103, v102, s71
    s_cmp_lt_u32 s61, 2
    s_cbranch_scc1 K2_one_block
    buffer_load_dword v32, v32, s[28:31], 0 offen
    buffer_load_dword v33, v33, s[28:31], 0 offen
    buffer_load_dword v34, v34, s[28:31], 0 offen
    buffer_load_dword v35, v35, s[28:31], 0 offen
    buffer_load_dword v36, v36, s[28:31], 0 offen
    buffer_load_dword v37, v37, s[28:31], 0 offen
    buffer_load_dword v38, v38, s[28:31], 0 offen
    buffer_load_dword v39, v39, s[28:31], 0 offen
    buffer_load_dword v40, v40, s[28:31], 0 offen
    buffer_load_dword v41, v41, s[28:31], 0 offen
    buffer_load_dword v42, v42, s[28:31], 0 offen
    buffer_load_dword v43, v43, s[28:31], 0 offen
    buffer_load_dword v44, v44, s[28:31], 0 offen
    buffer_load_dword v45, v45, s[28:31], 0 offen
    buffer_load_dword v46, v46, s[28:31], 0 offen
    buffer_load_dword v47, v47, s[28:31], 0 offen
K2_one_block:
    s_cmp_lg_u32 s39, 0
    s_cbranch_scc1 K2_xl1
    s_mul_i32 s41, s37, 5120
    v_lshl_add_u32 v15, v0, 3, s41
    v_min_u32 v15, 1279992, v15
    global_load_dwordx2 v[12:13], v15, s[4:5]
K2_xl1:
    s_cmp_gt_u32 s61, 2
    s_cbranch_scc0 K2_t0
K2_m0:
    s_waitcnt lgkmcnt(0)
    v_mfma_f32_32x32x16_bf16 v[64:79], v[84:87], v[88:91], v[112:127]
    s_add_u32 s62, s62, 1
    ds_read_b128 v[48:51], v3 offset:52608
    ds_read_b128 v[52:55], v3 offset:52624
    ds_read_b128 v[56:59], v3 offset:52640
    ds_read_b128 v[60:63], v3 offset:52656
    ds_read_b64 v[84:85], v4 offset:128
    v_readlane_b32 s65, v7, s62
    s_mov_b32 s67, 0
    s_cmp_eq_u32 s65, s66
    s_cbranch_scc0 K2_m0_reload
K2_m0_loaded:
    s_waitcnt vmcnt(16)
    v_mfma_f32_16x16x32_bf16 v[64:67], v[80:83], v[16:19], v[64:67]
    v_mfma_f32_16x16x32_bf16 v[68:71], v[80:83], v[20:23], v[68:71]
    v_mfma_f32_16x16x32_bf16 v[72:75], v[80:83], v[24:27], v[72:75]
    v_mfma_f32_16x16x32_bf16 v[76:79], v[80:83], v[28:31], v[76:79]
    s_waitcnt lgkmcnt(1)
    buffer_load_dword v48, v48, s[28:31], 0 offen
    buffer_load_dword v49, v49, s[28:31], 0 offen
    buffer_load_dword v50, v50, s[28:31], 0 offen
    buffer_load_dword v51, v51, s[28:31], 0 offen
    buffer_load_dword v52, v52, s[28:31], 0 offen
    buffer_load_dword v53, v53, s[28:31], 0 offen
    buffer_load_dword v54, v54, s[28:31], 0 offen
    buffer_load_dword v55, v55, s[28:31], 0 offen
    buffer_load_dword v56, v56, s[28:31], 0 offen
    buffer_load_dword v57, v57, s[28:31], 0 offen
    buffer_load_dword v58, v58, s[28:31], 0 offen
    buffer_load_dword v59, v59, s[28:31], 0 offen
    buffer_load_dword v60, v60, s[28:31], 0 offen
    buffer_load_dword v61, v61, s[28:31], 0 offen
    buffer_load_dword v62, v62, s[28:31], 0 offen
    buffer_load_dword v63, v63, s[28:31], 0 offen
    v_exp_f32_e64 v64, v64 clamp
    v_exp_f32_e64 v65, v65 clamp
    v_exp_f32_e64 v66, v66 clamp
    v_exp_f32_e64 v67, v67 clamp
    v_exp_f32_e64 v68, v68 clamp
    v_exp_f32_e64 v69, v69 clamp
    v_exp_f32_e64 v70, v70 clamp
    v_exp_f32_e64 v71, v71 clamp
    v_exp_f32_e64 v72, v72 clamp
    v_exp_f32_e64 v73, v73 clamp
    v_exp_f32_e64 v74, v74 clamp
    v_exp_f32_e64 v75, v75 clamp
    v_exp_f32_e64 v76, v76 clamp
    v_exp_f32_e64 v77, v77 clamp
    v_exp_f32_e64 v78, v78 clamp
    v_exp_f32_e64 v79, v79 clamp
    s_nop 1
    v_mfma_f32_32x32x8_bf16 v[64:79], v[92:93], v[94:95], v[64:79]
    s_cmp_lg_u32 s67, 0
    s_cbranch_scc1 K2_m0_pack
K2_m0_packed:
    s_and_b32 s69, s64, 0xff
    s_mul_i32 s69, s69, 0x01010101
    s_and_b32 s70, s64, 0xff
    s_xor_b32 s69, s69, s64
    s_xor_b32 s70, s70, s63
    s_or_b32 s69, s69, s70
    s_nop 3
    v_pk_mul_f32 v[100:101], v[64:65], v[66:67]
    v_pk_mul_f32 v[102:103], v[68:69], v[70:71]
    v_pk_mul_f32 v[108:109], v[72:73], v[74:75]
    v_pk_mul_f32 v[110:111], v[76:77], v[78:79]
    v_rcp_f32 v100, v100
    v_rcp_f32 v101, v101
    v_rcp_f32 v102, v102
    v_rcp_f32 v103, v103
    v_rcp_f32 v108, v108
    v_rcp_f32 v109, v109
    v_rcp_f32 v110, v110
    v_rcp_f32 v111, v111
    v_pk_mul_f32 v[16:17], v[66:67], v[16:17]
    v_pk_mul_f32 v[20:21], v[70:71], v[20:21]
    v_pk_mul_f32 v[24:25], v[74:75], v[24:25]
    v_pk_mul_f32 v[28:29], v[78:79], v[28:29]
    v_pk_fma_f32 v[16:17], v[64:65], v[18:19], v[16:17]
    v_pk_fma_f32 v[20:21], v[68:69], v[22:23], v[20:21]
    v_pk_fma_f32 v[24:25], v[72:73], v[26:27], v[24:25]
    v_pk_fma_f32 v[28:29], v[76:77], v[30:31], v[28:29]
    v_pk_add_f32 v[64:65], v[64:65], v[66:67]
    v_pk_add_f32 v[68:69], v[68:69], v[70:71]
    v_pk_add_f32 v[72:73], v[72:73], v[74:75]
    v_pk_add_f32 v[76:77], v[76:77], v[78:79]
    s_cbranch_scc1 K2_m0_slow
    v_pk_fma_f32 v[96:97], v[100:101], v[64:65], v[96:97]
    v_pk_fma_f32 v[98:99], v[100:101], v[16:17], v[98:99]
    v_pk_fma_f32 v[96:97], v[102:103], v[68:69], v[96:97]
    v_pk_fma_f32 v[98:99], v[102:103], v[20:21], v[98:99]
    v_pk_fma_f32 v[96:97], v[108:109], v[72:73], v[96:97]
    v_pk_fma_f32 v[98:99], v[108:109], v[24:25], v[98:99]
    v_pk_fma_f32 v[96:97], v[110:111], v[76:77], v[96:97]
    v_pk_fma_f32 v[98:99], v[110:111], v[28:29], v[98:99]
K2_m0_next:
    s_mov_b32 s64, s65
    s_add_u32 s69, s62, 2
    s_cmp_lt_u32 s69, s61
    s_cbranch_scc0 K2_t1
K2_m1:
    s_waitcnt lgkmcnt(0)
    v_mfma_f32_32x32x16_bf16 v[64:79], v[84:87], v[88:91], v[112:127]
    s_add_u32 s62, s62, 1
    ds_read_b128 v[16:19], v3 offset:52672
    ds_read_b128 v[20:23], v3 offset:52688
    ds_read_b128 v[24:27], v3 offset:52704
    ds_read_b128 v[28:31], v3 offset:52720
    ds_read_b64 v[84:85], v4 offset:256
    v_readlane_b32 s65, v7, s62
    s_mov_b32 s67, 0
    s_cmp_eq_u32 s65, s66
    s_cbranch_scc0 K2_m1_reload
K2_m1_loaded:
    s_waitcnt vmcnt(16)
    v_mfma_f32_16x16x32_bf16 v[64:67], v[80:83], v[32:35], v[64:67]
    v_mfma_f32_16x16x32_bf16 v[68:71], v[80:83], v[36:39], v[68:71]
    v_mfma_f32_16x16x32_bf16 v[72:75], v[80:83], v[40:43], v[72:75]
    v_mfma_f32_16x16x32_bf16 v[76:79], v[80:83], v[44:47], v[76:79]
    s_waitcnt lgkmcnt(1)
    buffer_load_dword v16, v16, s[28:31], 0 offen
    buffer_load_dword v17, v17, s[28:31], 0 offen
    buffer_load_dword v18, v18, s[28:31], 0 offen
    buffer_load_dword v19, v19, s[28:31], 0 offen
    buffer_load_dword v20, v20, s[28:31], 0 offen
    buffer_load_dword v21, v21, s[28:31], 0 offen
    buffer_load_dword v22, v22, s[28:31], 0 offen
    buffer_load_dword v23, v23, s[28:31], 0 offen
    buffer_load_dword v24, v24, s[28:31], 0 offen
    buffer_load_dword v25, v25, s[28:31], 0 offen
    buffer_load_dword v26, v26, s[28:31], 0 offen
    buffer_load_dword v27, v27, s[28:31], 0 offen
    buffer_load_dword v28, v28, s[28:31], 0 offen
    buffer_load_dword v29, v29, s[28:31], 0 offen
    buffer_load_dword v30, v30, s[28:31], 0 offen
    buffer_load_dword v31, v31, s[28:31], 0 offen
    v_exp_f32_e64 v64, v64 clamp
    v_exp_f32_e64 v65, v65 clamp
    v_exp_f32_e64 v66, v66 clamp
    v_exp_f32_e64 v67, v67 clamp
    v_exp_f32_e64 v68, v68 clamp
    v_exp_f32_e64 v69, v69 clamp
    v_exp_f32_e64 v70, v70 clamp
    v_exp_f32_e64 v71, v71 clamp
    v_exp_f32_e64 v72, v72 clamp
    v_exp_f32_e64 v73, v73 clamp
    v_exp_f32_e64 v74, v74 clamp
    v_exp_f32_e64 v75, v75 clamp
    v_exp_f32_e64 v76, v76 clamp
    v_exp_f32_e64 v77, v77 clamp
    v_exp_f32_e64 v78, v78 clamp
    v_exp_f32_e64 v79, v79 clamp
    s_nop 1
    v_mfma_f32_32x32x8_bf16 v[64:79], v[92:93], v[94:95], v[64:79]
    s_cmp_lg_u32 s67, 0
    s_cbranch_scc1 K2_m1_pack
K2_m1_packed:
    s_and_b32 s69, s64, 0xff
    s_mul_i32 s69, s69, 0x01010101
    s_and_b32 s70, s64, 0xff
    s_xor_b32 s69, s69, s64
    s_xor_b32 s70, s70, s63
    s_or_b32 s69, s69, s70
    s_nop 3
    v_pk_mul_f32 v[100:101], v[64:65], v[66:67]
    v_pk_mul_f32 v[102:103], v[68:69], v[70:71]
    v_pk_mul_f32 v[108:109], v[72:73], v[74:75]
    v_pk_mul_f32 v[110:111], v[76:77], v[78:79]
    v_rcp_f32 v100, v100
    v_rcp_f32 v101, v101
    v_rcp_f32 v102, v102
    v_rcp_f32 v103, v103
    v_rcp_f32 v108, v108
    v_rcp_f32 v109, v109
    v_rcp_f32 v110, v110
    v_rcp_f32 v111, v111
    v_pk_mul_f32 v[32:33], v[66:67], v[32:33]
    v_pk_mul_f32 v[36:37], v[70:71], v[36:37]
    v_pk_mul_f32 v[40:41], v[74:75], v[40:41]
    v_pk_mul_f32 v[44:45], v[78:79], v[44:45]
    v_pk_fma_f32 v[32:33], v[64:65], v[34:35], v[32:33]
    v_pk_fma_f32 v[36:37], v[68:69], v[38:39], v[36:37]
    v_pk_fma_f32 v[40:41], v[72:73], v[42:43], v[40:41]
    v_pk_fma_f32 v[44:45], v[76:77], v[46:47], v[44:45]
    v_pk_add_f32 v[64:65], v[64:65], v[66:67]
    v_pk_add_f32 v[68:69], v[68:69], v[70:71]
    v_pk_add_f32 v[72:73], v[72:73], v[74:75]
    v_pk_add_f32 v[76:77], v[76:77], v[78:79]
    s_cbranch_scc1 K2_m1_slow
    v_pk_fma_f32 v[96:97], v[100:101], v[64:65], v[96:97]
    v_pk_fma_f32 v[98:99], v[100:101], v[32:33], v[98:99]
    v_pk_fma_f32 v[96:97], v[102:103], v[68:69], v[96:97]
    v_pk_fma_f32 v[98:99], v[102:103], v[36:37], v[98:99]
    v_pk_fma_f32 v[96:97], v[108:109], v[72:73], v[96:97]
    v_pk_fma_f32 v[98:99], v[108:109], v[40:41], v[98:99]
    v_pk_fma_f32 v[96:97], v[110:111], v[76:77], v[96:97]
    v_pk_fma_f32 v[98:99], v[110:111], v[44:45], v[98:99]
K2_m1_next:
    s_mov_b32 s64, s65
    s_add_u32 s69, s62, 2
    s_cmp_lt_u32 s69, s61
    s_cbranch_scc0 K2_t2
K2_m2:
    s_waitcnt lgkmcnt(0)
    v_mfma_f32_32x32x16_bf16 v[64:79], v[84:87], v[88:91], v[112:127]
    s_add_u32 s62, s62, 1
    ds_read_b128 v[32:35], v3 offset:52736
    ds_read_b128 v[36:39], v3 offset:52752
    ds_read_b128 v[40:43], v3 offset:52768
    ds_read_b128 v[44:47], v3 offset:52784
    ds_read_b64 v[84:85], v4 offset:384
    v_add_u32 v3, 0xc0, v3
    v_add_u32 v4, v5, v4
    v_readlane_b32 s65, v7, s62
    s_mov_b32 s67, 0
    s_cmp_eq_u32 s65, s66
    s_cbranch_scc0 K2_m2_reload
K2_m2_loaded:
    s_waitcnt vmcnt(16)
    v_mfma_f32_16x16x32_bf16 v[64:67], v[80:83], v[48:51], v[64:67]
    v_mfma_f32_16x16x32_bf16 v[68:71], v[80:83], v[52:55], v[68:71]
    v_mfma_f32_16x16x32_bf16 v[72:75], v[80:83], v[56:59], v[72:75]
    v_mfma_f32_16x16x32_bf16 v[76:79], v[80:83], v[60:63], v[76:79]
    s_waitcnt lgkmcnt(1)
    buffer_load_dword v32, v32, s[28:31], 0 offen
    buffer_load_dword v33, v33, s[28:31], 0 offen
    buffer_load_dword v34, v34, s[28:31], 0 offen
    buffer_load_dword v35, v35, s[28:31], 0 offen
    buffer_load_dword v36, v36, s[28:31], 0 offen
    buffer_load_dword v37, v37, s[28:31], 0 offen
    buffer_load_dword v38, v38, s[28:31], 0 offen
    buffer_load_dword v39, v39, s[28:31], 0 offen
    buffer_load_dword v40, v40, s[28:31], 0 offen
    buffer_load_dword v41, v41, s[28:31], 0 offen
    buffer_load_dword v42, v42, s[28:31], 0 offen
    buffer_load_dword v43, v43, s[28:31], 0 offen
    buffer_load_dword v44, v44, s[28:31], 0 offen
    buffer_load_dword v45, v45, s[28:31], 0 offen
    buffer_load_dword v46, v46, s[28:31], 0 offen
    buffer_load_dword v47, v47, s[28:31], 0 offen
    v_exp_f32_e64 v64, v64 clamp
    v_exp_f32_e64 v65, v65 clamp
    v_exp_f32_e64 v66, v66 clamp
    v_exp_f32_e64 v67, v67 clamp
    v_exp_f32_e64 v68, v68 clamp
    v_exp_f32_e64 v69, v69 clamp
    v_exp_f32_e64 v70, v70 clamp
    v_exp_f32_e64 v71, v71 clamp
    v_exp_f32_e64 v72, v72 clamp
    v_exp_f32_e64 v73, v73 clamp
    v_exp_f32_e64 v74, v74 clamp
    v_exp_f32_e64 v75, v75 clamp
    v_exp_f32_e64 v76, v76 clamp
    v_exp_f32_e64 v77, v77 clamp
    v_exp_f32_e64 v78, v78 clamp
    v_exp_f32_e64 v79, v79 clamp
    s_nop 1
    v_mfma_f32_32x32x8_bf16 v[64:79], v[92:93], v[94:95], v[64:79]
    s_cmp_lg_u32 s67, 0
    s_cbranch_scc1 K2_m2_pack
K2_m2_packed:
    s_and_b32 s69, s64, 0xff
    s_mul_i32 s69, s69, 0x01010101
    s_and_b32 s70, s64, 0xff
    s_xor_b32 s69, s69, s64
    s_xor_b32 s70, s70, s63
    s_or_b32 s69, s69, s70
    s_nop 3
    v_pk_mul_f32 v[100:101], v[64:65], v[66:67]
    v_pk_mul_f32 v[102:103], v[68:69], v[70:71]
    v_pk_mul_f32 v[108:109], v[72:73], v[74:75]
    v_pk_mul_f32 v[110:111], v[76:77], v[78:79]
    v_rcp_f32 v100, v100
    v_rcp_f32 v101, v101
    v_rcp_f32 v102, v102
    v_rcp_f32 v103, v103
    v_rcp_f32 v108, v108
    v_rcp_f32 v109, v109
    v_rcp_f32 v110, v110
    v_rcp_f32 v111, v111
    v_pk_mul_f32 v[48:49], v[66:67], v[48:49]
    v_pk_mul_f32 v[52:53], v[70:71], v[52:53]
    v_pk_mul_f32 v[56:57], v[74:75], v[56:57]
    v_pk_mul_f32 v[60:61], v[78:79], v[60:61]
    v_pk_fma_f32 v[48:49], v[64:65], v[50:51], v[48:49]
    v_pk_fma_f32 v[52:53], v[68:69], v[54:55], v[52:53]
    v_pk_fma_f32 v[56:57], v[72:73], v[58:59], v[56:57]
    v_pk_fma_f32 v[60:61], v[76:77], v[62:63], v[60:61]
    v_pk_add_f32 v[64:65], v[64:65], v[66:67]
    v_pk_add_f32 v[68:69], v[68:69], v[70:71]
    v_pk_add_f32 v[72:73], v[72:73], v[74:75]
    v_pk_add_f32 v[76:77], v[76:77], v[78:79]
    s_cbranch_scc1 K2_m2_slow
    v_pk_fma_f32 v[96:97], v[100:101], v[64:65], v[96:97]
    v_pk_fma_f32 v[98:99], v[100:101], v[48:49], v[98:99]
    v_pk_fma_f32 v[96:97], v[102:103], v[68:69], v[96:97]
    v_pk_fma_f32 v[98:99], v[102:103], v[52:53], v[98:99]
    v_pk_fma_f32 v[96:97], v[108:109], v[72:73], v[96:97]
    v_pk_fma_f32 v[98:99], v[108:109], v[56:57], v[98:99]
    v_pk_fma_f32 v[96:97], v[110:111], v[76:77], v[96:97]
    v_pk_fma_f32 v[98:99], v[110:111], v[60:61], v[98:99]
K2_m2_next:
    s_mov_b32 s64, s65
    s_add_u32 s69, s62, 2
    s_cmp_lt_u32 s69, s61
    s_cbranch_scc0 K2_t0
    s_cmp_lt_u32 s62, 6
    s_cbranch_scc1 K2_m0
    s_setprio 2
    s_branch K2_m0
K2_t0:
    s_add_u32 s69, s62, 1
    s_cmp_eq_u32 s69, s61
    s_cbranch_scc1 K2_t0_p0
    s_setprio 1
    s_branch K2_t0_pd
K2_t0_p0:
    s_setprio 0
K2_t0_pd:
    s_waitcnt lgkmcnt(0)
    v_mfma_f32_32x32x16_bf16 v[64:79], v[84:87], v[88:91], v[112:127]
    s_add_u32 s62, s62, 1
    ds_read_b64 v[84:85], v4 offset:128
    v_readlane_b32 s65, v7, s62
    s_mov_b32 s67, 0
    s_cmp_eq_u32 s65, s66
    s_cbranch_scc0 K2_t0_reload
K2_t0_loaded:
    s_nop 3
    s_waitcnt vmcnt(0)
    v_mfma_f32_16x16x32_bf16 v[64:67], v[80:83], v[16:19], v[64:67]
    v_mfma_f32_16x16x32_bf16 v[68:71], v[80:83], v[20:23], v[68:71]
    v_mfma_f32_16x16x32_bf16 v[72:75], v[80:83], v[24:27], v[72:75]
    v_mfma_f32_16x16x32_bf16 v[76:79], v[80:83], v[28:31], v[76:79]
    s_nop 7
    v_exp_f32_e64 v64, v64 clamp
    v_exp_f32_e64 v65, v65 clamp
    v_exp_f32_e64 v66, v66 clamp
    v_exp_f32_e64 v67, v67 clamp
    v_exp_f32_e64 v68, v68 clamp
    v_exp_f32_e64 v69, v69 clamp
    v_exp_f32_e64 v70, v70 clamp
    v_exp_f32_e64 v71, v71 clamp
    v_exp_f32_e64 v72, v72 clamp
    v_exp_f32_e64 v73, v73 clamp
    v_exp_f32_e64 v74, v74 clamp
    v_exp_f32_e64 v75, v75 clamp
    v_exp_f32_e64 v76, v76 clamp
    v_exp_f32_e64 v77, v77 clamp
    v_exp_f32_e64 v78, v78 clamp
    v_exp_f32_e64 v79, v79 clamp
    s_nop 1
    v_mfma_f32_32x32x8_bf16 v[64:79], v[92:93], v[94:95], v[64:79]
    s_cmp_lg_u32 s67, 0
    s_cbranch_scc1 K2_t0_pack
K2_t0_packed:
    s_and_b32 s69, s64, 0xff
    s_mul_i32 s69, s69, 0x01010101
    s_and_b32 s70, s64, 0xff
    s_xor_b32 s69, s69, s64
    s_xor_b32 s70, s70, s63
    s_or_b32 s69, s69, s70
    s_nop 3
    v_pk_mul_f32 v[100:101], v[64:65], v[66:67]
    v_pk_mul_f32 v[102:103], v[68:69], v[70:71]
    v_pk_mul_f32 v[108:109], v[72:73], v[74:75]
    v_pk_mul_f32 v[110:111], v[76:77], v[78:79]
    v_rcp_f32 v100, v100
    v_rcp_f32 v101, v101
    v_rcp_f32 v102, v102
    v_rcp_f32 v103, v103
    v_rcp_f32 v108, v108
    v_rcp_f32 v109, v109
    v_rcp_f32 v110, v110
    v_rcp_f32 v111, v111
    v_pk_mul_f32 v[16:17], v[66:67], v[16:17]
    v_pk_mul_f32 v[20:21], v[70:71], v[20:21]
    v_pk_mul_f32 v[24:25], v[74:75], v[24:25]
    v_pk_mul_f32 v[28:29], v[78:79], v[28:29]
    v_pk_fma_f32 v[16:17], v[64:65], v[18:19], v[16:17]
    v_pk_fma_f32 v[20:21], v[68:69], v[22:23], v[20:21]
    v_pk_fma_f32 v[24:25], v[72:73], v[26:27], v[24:25]
    v_pk_fma_f32 v[28:29], v[76:77], v[30:31], v[28:29]
    v_pk_add_f32 v[64:65], v[64:65], v[66:67]
    v_pk_add_f32 v[68:69], v[68:69], v[70:71]
    v_pk_add_f32 v[72:73], v[72:73], v[74:75]
    v_pk_add_f32 v[76:77], v[76:77], v[78:79]
    s_cbranch_scc1 K2_t0_slow
    v_pk_fma_f32 v[96:97], v[100:101], v[64:65], v[96:97]
    v_pk_fma_f32 v[98:99], v[100:101], v[16:17], v[98:99]
    v_pk_fma_f32 v[96:97], v[102:103], v[68:69], v[96:97]
    v_pk_fma_f32 v[98:99], v[102:103], v[20:21], v[98:99]
    v_pk_fma_f32 v[96:97], v[108:109], v[72:73], v[96:97]
    v_pk_fma_f32 v[98:99], v[108:109], v[24:25], v[98:99]
    v_pk_fma_f32 v[96:97], v[110:111], v[76:77], v[96:97]
    v_pk_fma_f32 v[98:99], v[110:111], v[28:29], v[98:99]
K2_t0_next:
    s_mov_b32 s64, s65
    s_cmp_lt_u32 s62, s61
    s_cbranch_scc0 K2_range_end
K2_t1:
    s_add_u32 s69, s62, 1
    s_cmp_eq_u32 s69, s61
    s_cbranch_scc1 K2_t1_p0
    s_setprio 1
    s_branch K2_t1_pd
K2_t1_p0:
    s_setprio 0
K2_t1_pd:
    s_waitcnt lgkmcnt(0)
    v_mfma_f32_32x32x16_bf16 v[64:79], v[84:87], v[88:91], v[112:127]
    s_add_u32 s62, s62, 1
    ds_read_b64 v[84:85], v4 offset:256
    v_readlane_b32 s65, v7, s62
    s_mov_b32 s67, 0
    s_cmp_eq_u32 s65, s66
    s_cbranch_scc0 K2_t1_reload
K2_t1_loaded:
    s_nop 3
    s_waitcnt vmcnt(0)
    v_mfma_f32_16x16x32_bf16 v[64:67], v[80:83], v[32:35], v[64:67]
    v_mfma_f32_16x16x32_bf16 v[68:71], v[80:83], v[36:39], v[68:71]
    v_mfma_f32_16x16x32_bf16 v[72:75], v[80:83], v[40:43], v[72:75]
    v_mfma_f32_16x16x32_bf16 v[76:79], v[80:83], v[44:47], v[76:79]
    s_nop 7
    v_exp_f32_e64 v64, v64 clamp
    v_exp_f32_e64 v65, v65 clamp
    v_exp_f32_e64 v66, v66 clamp
    v_exp_f32_e64 v67, v67 clamp
    v_exp_f32_e64 v68, v68 clamp
    v_exp_f32_e64 v69, v69 clamp
    v_exp_f32_e64 v70, v70 clamp
    v_exp_f32_e64 v71, v71 clamp
    v_exp_f32_e64 v72, v72 clamp
    v_exp_f32_e64 v73, v73 clamp
    v_exp_f32_e64 v74, v74 clamp
    v_exp_f32_e64 v75, v75 clamp
    v_exp_f32_e64 v76, v76 clamp
    v_exp_f32_e64 v77, v77 clamp
    v_exp_f32_e64 v78, v78 clamp
    v_exp_f32_e64 v79, v79 clamp
    s_nop 1
    v_mfma_f32_32x32x8_bf16 v[64:79], v[92:93], v[94:95], v[64:79]
    s_cmp_lg_u32 s67, 0
    s_cbranch_scc1 K2_t1_pack
K2_t1_packed:
    s_and_b32 s69, s64, 0xff
    s_mul_i32 s69, s69, 0x01010101
    s_and_b32 s70, s64, 0xff
    s_xor_b32 s69, s69, s64
    s_xor_b32 s70, s70, s63
    s_or_b32 s69, s69, s70
    s_nop 3
    v_pk_mul_f32 v[100:101], v[64:65], v[66:67]
    v_pk_mul_f32 v[102:103], v[68:69], v[70:71]
    v_pk_mul_f32 v[108:109], v[72:73], v[74:75]
    v_pk_mul_f32 v[110:111], v[76:77], v[78:79]
    v_rcp_f32 v100, v100
    v_rcp_f32 v101, v101
    v_rcp_f32 v102, v102
    v_rcp_f32 v103, v103
    v_rcp_f32 v108, v108
    v_rcp_f32 v109, v109
    v_rcp_f32 v110, v110
    v_rcp_f32 v111, v111
    v_pk_mul_f32 v[32:33], v[66:67], v[32:33]
    v_pk_mul_f32 v[36:37], v[70:71], v[36:37]
    v_pk_mul_f32 v[40:41], v[74:75], v[40:41]
    v_pk_mul_f32 v[44:45], v[78:79], v[44:45]
    v_pk_fma_f32 v[32:33], v[64:65], v[34:35], v[32:33]
    v_pk_fma_f32 v[36:37], v[68:69], v[38:39], v[36:37]
    v_pk_fma_f32 v[40:41], v[72:73], v[42:43], v[40:41]
    v_pk_fma_f32 v[44:45], v[76:77], v[46:47], v[44:45]
    v_pk_add_f32 v[64:65], v[64:65], v[66:67]
    v_pk_add_f32 v[68:69], v[68:69], v[70:71]
    v_pk_add_f32 v[72:73], v[72:73], v[74:75]
    v_pk_add_f32 v[76:77], v[76:77], v[78:79]
    s_cbranch_scc1 K2_t1_slow
    v_pk_fma_f32 v[96:97], v[100:101], v[64:65], v[96:97]
    v_pk_fma_f32 v[98:99], v[100:101], v[32:33], v[98:99]
    v_pk_fma_f32 v[96:97], v[102:103], v[68:69], v[96:97]
    v_pk_fma_f32 v[98:99], v[102:103], v[36:37], v[98:99]
    v_pk_fma_f32 v[96:97], v[108:109], v[72:73], v[96:97]
    v_pk_fma_f32 v[98:99], v[108:109], v[40:41], v[98:99]
    v_pk_fma_f32 v[96:97], v[110:111], v[76:77], v[96:97]
    v_pk_fma_f32 v[98:99], v[110:111], v[44:45], v[98:99]
K2_t1_next:
    s_mov_b32 s64, s65
    s_cmp_lt_u32 s62, s61
    s_cbranch_scc0 K2_range_end
K2_t2:
    s_add_u32 s69, s62, 1
    s_cmp_eq_u32 s69, s61
    s_cbranch_scc1 K2_t2_p0
    s_setprio 1
    s_branch K2_t2_pd
K2_t2_p0:
    s_setprio 0
K2_t2_pd:
    s_waitcnt lgkmcnt(0)
    v_mfma_f32_32x32x16_bf16 v[64:79], v[84:87], v[88:91], v[112:127]
    s_add_u32 s62, s62, 1
    ds_read_b64 v[84:85], v4 offset:384
    v_add_u32 v4, v5, v4
    v_readlane_b32 s65, v7, s62
    s_mov_b32 s67, 0
    s_cmp_eq_u32 s65, s66
    s_cbranch_scc0 K2_t2_reload
K2_t2_loaded:
    s_nop 3
    s_waitcnt vmcnt(0)
    v_mfma_f32_16x16x32_bf16 v[64:67], v[80:83], v[48:51], v[64:67]
    v_mfma_f32_16x16x32_bf16 v[68:71], v[80:83], v[52:55], v[68:71]
    v_mfma_f32_16x16x32_bf16 v[72:75], v[80:83], v[56:59], v[72:75]
    v_mfma_f32_16x16x32_bf16 v[76:79], v[80:83], v[60:63], v[76:79]
    s_nop 7
    v_exp_f32_e64 v64, v64 clamp
    v_exp_f32_e64 v65, v65 clamp
    v_exp_f32_e64 v66, v66 clamp
    v_exp_f32_e64 v67, v67 clamp
    v_exp_f32_e64 v68, v68 clamp
    v_exp_f32_e64 v69, v69 clamp
    v_exp_f32_e64 v70, v70 clamp
    v_exp_f32_e64 v71, v71 clamp
    v_exp_f32_e64 v72, v72 clamp
    v_exp_f32_e64 v73, v73 clamp
    v_exp_f32_e64 v74, v74 clamp
    v_exp_f32_e64 v75, v75 clamp
    v_exp_f32_e64 v76, v76 clamp
    v_exp_f32_e64 v77, v77 clamp
    v_exp_f32_e64 v78, v78 clamp
    v_exp_f32_e64 v79, v79 clamp
    s_nop 1
    v_mfma_f32_32x32x8_bf16 v[64:79], v[92:93], v[94:95], v[64:79]
    s_cmp_lg_u32 s67, 0
    s_cbranch_scc1 K2_t2_pack
K2_t2_packed:
    s_and_b32 s69, s64, 0xff
    s_mul_i32 s69, s69, 0x01010101
    s_and_b32 s70, s64, 0xff
    s_xor_b32 s69, s69, s64
    s_xor_b32 s70, s70, s63
    s_or_b32 s69, s69, s70
    s_nop 3
    v_pk_mul_f32 v[100:101], v[64:65], v[66:67]
    v_pk_mul_f32 v[102:103], v[68:69], v[70:71]
    v_pk_mul_f32 v[108:109], v[72:73], v[74:75]
    v_pk_mul_f32 v[110:111], v[76:77], v[78:79]
    v_rcp_f32 v100, v100
    v_rcp_f32 v101, v101
    v_rcp_f32 v102, v102
    v_rcp_f32 v103, v103
    v_rcp_f32 v108, v108
    v_rcp_f32 v109, v109
    v_rcp_f32 v110, v110
    v_rcp_f32 v111, v111
    v_pk_mul_f32 v[48:49], v[66:67], v[48:49]
    v_pk_mul_f32 v[52:53], v[70:71], v[52:53]
    v_pk_mul_f32 v[56:57], v[74:75], v[56:57]
    v_pk_mul_f32 v[60:61], v[78:79], v[60:61]
    v_pk_fma_f32 v[48:49], v[64:65], v[50:51], v[48:49]
    v_pk_fma_f32 v[52:53], v[68:69], v[54:55], v[52:53]
    v_pk_fma_f32 v[56:57], v[72:73], v[58:59], v[56:57]
    v_pk_fma_f32 v[60:61], v[76:77], v[62:63], v[60:61]
    v_pk_add_f32 v[64:65], v[64:65], v[66:67]
    v_pk_add_f32 v[68:69], v[68:69], v[70:71]
    v_pk_add_f32 v[72:73], v[72:73], v[74:75]
    v_pk_add_f32 v[76:77], v[76:77], v[78:79]
    s_cbranch_scc1 K2_t2_slow
    v_pk_fma_f32 v[96:97], v[100:101], v[64:65], v[96:97]
    v_pk_fma_f32 v[98:99], v[100:101], v[48:49], v[98:99]
    v_pk_fma_f32 v[96:97], v[102:103], v[68:69], v[96:97]
    v_pk_fma_f32 v[98:99], v[102:103], v[52:53], v[98:99]
    v_pk_fma_f32 v[96:97], v[108:109], v[72:73], v[96:97]
    v_pk_fma_f32 v[98:99], v[108:109], v[56:57], v[98:99]
    v_pk_fma_f32 v[96:97], v[110:111], v[76:77], v[96:97]
    v_pk_fma_f32 v[98:99], v[110:111], v[60:61], v[98:99]
K2_t2_next:
    s_mov_b32 s64, s65
    s_cmp_lt_u32 s62, s61
    s_cbranch_scc0 K2_range_end
    s_branch K2_t0
K2_m0_reload:
    s_mov_b32 s66, s65
    s_and_b32 s69, s65, 0xff
    s_mul_i32 s70, s69, 0x01010101
    s_cmp_eq_u32 s70, s65
    s_cbranch_scc0 K2_m0_mixed
    s_lshl_b32 s69, s69, 6
    v_add_u32 v15, s69, v106
    ds_read2_b32 v[90:91], v15 offset0:0 offset1:0
    s_branch K2_m0_loaded
K2_m0_mixed:
    s_bfe_u32 s69, s65, 0x80000
    s_lshl_b32 s69, s69, 6
    v_add_u32 v15, s69, v106
    ds_read_b32 v100, v15
    s_bfe_u32 s69, s65, 0x80008
    s_lshl_b32 s69, s69, 6
    v_add_u32 v15, s69, v106
    ds_read_b32 v101, v15
    s_bfe_u32 s69, s65, 0x80010
    s_lshl_b32 s69, s69, 6
    v_add_u32 v15, s69, v106
    ds_read_b32 v102, v15
    s_bfe_u32 s69, s65, 0x80018
    s_lshl_b32 s69, s69, 6
    v_add_u32 v15, s69, v106
    ds_read_b32 v103, v15
    s_mov_b32 s67, 1
    s_branch K2_m0_loaded
K2_m0_pack:
    s_waitcnt lgkmcnt(0)
    v_perm_b32 v90, v101, v100, s71
    v_perm_b32 v91, v103, v102, s71
    s_branch K2_m0_packed
K2_m0_slow:
    s_bfe_u32 s70, s64, 0x80000
    s_cmp_eq_u32 s70, s63
    s_cbranch_scc0 K2_m0_new0
    v_pk_fma_f32 v[96:97], v[100:101], v[64:65], v[96:97]
    v_pk_fma_f32 v[98:99], v[100:101], v[16:17], v[98:99]
K2_m0_g0:
    s_bfe_u32 s70, s64, 0x80008
    s_cmp_eq_u32 s70, s63
    s_cbranch_scc0 K2_m0_new1
    v_pk_fma_f32 v[96:97], v[102:103], v[68:69], v[96:97]
    v_pk_fma_f32 v[98:99], v[102:103], v[20:21], v[98:99]
K2_m0_g1:
    s_bfe_u32 s70, s64, 0x80010
    s_cmp_eq_u32 s70, s63
    s_cbranch_scc0 K2_m0_new2
    v_pk_fma_f32 v[96:97], v[108:109], v[72:73], v[96:97]
    v_pk_fma_f32 v[98:99], v[108:109], v[24:25], v[98:99]
K2_m0_g2:
    s_bfe_u32 s70, s64, 0x80018
    s_cmp_eq_u32 s70, s63
    s_cbranch_scc0 K2_m0_new3
    v_pk_fma_f32 v[96:97], v[110:111], v[76:77], v[96:97]
    v_pk_fma_f32 v[98:99], v[110:111], v[28:29], v[98:99]
K2_m0_g3:
    s_branch K2_m0_next
K2_m0_new0:
    v_add_u32 v15, s68, v2
    v_add_f32 v104, v96, v97
    v_add_f32 v105, v98, v99
    s_cmp_lg_u32 s39, 0
    s_cbranch_scc1 K2_m0_f0_atomic
    ds_write_b32 v15, v104 offset:14336
    ds_write_b32 v15, v105 offset:0
K2_m0_f0_flushed:
    s_mov_b32 s63, s70
    s_lshl_b32 s68, s70, 6
    v_pk_mul_f32 v[96:97], v[100:101], v[64:65]
    v_pk_mul_f32 v[98:99], v[100:101], v[16:17]
    s_branch K2_m0_g0
K2_m0_new1:
    v_add_u32 v15, s68, v2
    v_add_f32 v104, v96, v97
    v_add_f32 v105, v98, v99
    s_cmp_lg_u32 s39, 0
    s_cbranch_scc1 K2_m0_f1_atomic
    ds_write_b32 v15, v104 offset:14336
    ds_write_b32 v15, v105 offset:0
K2_m0_f1_flushed:
    s_mov_b32 s63, s70
    s_lshl_b32 s68, s70, 6
    v_pk_mul_f32 v[96:97], v[102:103], v[68:69]
    v_pk_mul_f32 v[98:99], v[102:103], v[20:21]
    s_branch K2_m0_g1
K2_m0_new2:
    v_add_u32 v15, s68, v2
    v_add_f32 v104, v96, v97
    v_add_f32 v105, v98, v99
    s_cmp_lg_u32 s39, 0
    s_cbranch_scc1 K2_m0_f2_atomic
    ds_write_b32 v15, v104 offset:14336
    ds_write_b32 v15, v105 offset:0
K2_m0_f2_flushed:
    s_mov_b32 s63, s70
    s_lshl_b32 s68, s70, 6
    v_pk_mul_f32 v[96:97], v[108:109], v[72:73]
    v_pk_mul_f32 v[98:99], v[108:109], v[24:25]
    s_branch K2_m0_g2
K2_m0_new3:
    v_add_u32 v15, s68, v2
    v_add_f32 v104, v96, v97
    v_add_f32 v105, v98, v99
    s_cmp_lg_u32 s39, 0
    s_cbranch_scc1 K2_m0_f3_atomic
    ds_write_b32 v15, v104 offset:14336
    ds_write_b32 v15, v105 offset:0
K2_m0_f3_flushed:
    s_mov_b32 s63, s70
    s_lshl_b32 s68, s70, 6
    v_pk_mul_f32 v[96:97], v[110:111], v[76:77]
    v_pk_mul_f32 v[98:99], v[110:111], v[28:29]
    s_branch K2_m0_g3
K2_m1_reload:
    s_mov_b32 s66, s65
    s_and_b32 s69, s65, 0xff
    s_mul_i32 s70, s69, 0x01010101
    s_cmp_eq_u32 s70, s65
    s_cbranch_scc0 K2_m1_mixed
    s_lshl_b32 s69, s69, 6
    v_add_u32 v15, s69, v106
    ds_read2_b32 v[90:91], v15 offset0:0 offset1:0
    s_branch K2_m1_loaded
K2_m1_mixed:
    s_bfe_u32 s69, s65, 0x80000
    s_lshl_b32 s69, s69, 6
    v_add_u32 v15, s69, v106
    ds_read_b32 v100, v15
    s_bfe_u32 s69, s65, 0x80008
    s_lshl_b32 s69, s69, 6
    v_add_u32 v15, s69, v106
    ds_read_b32 v101, v15
    s_bfe_u32 s69, s65, 0x80010
    s_lshl_b32 s69, s69, 6
    v_add_u32 v15, s69, v106
    ds_read_b32 v102, v15
    s_bfe_u32 s69, s65, 0x80018
    s_lshl_b32 s69, s69, 6
    v_add_u32 v15, s69, v106
    ds_read_b32 v103, v15
    s_mov_b32 s67, 1
    s_branch K2_m1_loaded
K2_m1_pack:
    s_waitcnt lgkmcnt(0)
    v_perm_b32 v90, v101, v100, s71
    v_perm_b32 v91, v103, v102, s71
    s_branch K2_m1_packed
K2_m1_slow:
    s_bfe_u32 s70, s64, 0x80000
    s_cmp_eq_u32 s70, s63
    s_cbranch_scc0 K2_m1_new0
    v_pk_fma_f32 v[96:97], v[100:101], v[64:65], v[96:97]
    v_pk_fma_f32 v[98:99], v[100:101], v[32:33], v[98:99]
K2_m1_g0:
    s_bfe_u32 s70, s64, 0x80008
    s_cmp_eq_u32 s70, s63
    s_cbranch_scc0 K2_m1_new1
    v_pk_fma_f32 v[96:97], v[102:103], v[68:69], v[96:97]
    v_pk_fma_f32 v[98:99], v[102:103], v[36:37], v[98:99]
K2_m1_g1:
    s_bfe_u32 s70, s64, 0x80010
    s_cmp_eq_u32 s70, s63
    s_cbranch_scc0 K2_m1_new2
    v_pk_fma_f32 v[96:97], v[108:109], v[72:73], v[96:97]
    v_pk_fma_f32 v[98:99], v[108:109], v[40:41], v[98:99]
K2_m1_g2:
    s_bfe_u32 s70, s64, 0x80018
    s_cmp_eq_u32 s70, s63
    s_cbranch_scc0 K2_m1_new3
    v_pk_fma_f32 v[96:97], v[110:111], v[76:77], v[96:97]
    v_pk_fma_f32 v[98:99], v[110:111], v[44:45], v[98:99]
K2_m1_g3:
    s_branch K2_m1_next
K2_m1_new0:
    v_add_u32 v15, s68, v2
    v_add_f32 v104, v96, v97
    v_add_f32 v105, v98, v99
    s_cmp_lg_u32 s39, 0
    s_cbranch_scc1 K2_m1_f0_atomic
    ds_write_b32 v15, v104 offset:14336
    ds_write_b32 v15, v105 offset:0
K2_m1_f0_flushed:
    s_mov_b32 s63, s70
    s_lshl_b32 s68, s70, 6
    v_pk_mul_f32 v[96:97], v[100:101], v[64:65]
    v_pk_mul_f32 v[98:99], v[100:101], v[32:33]
    s_branch K2_m1_g0
K2_m1_new1:
    v_add_u32 v15, s68, v2
    v_add_f32 v104, v96, v97
    v_add_f32 v105, v98, v99
    s_cmp_lg_u32 s39, 0
    s_cbranch_scc1 K2_m1_f1_atomic
    ds_write_b32 v15, v104 offset:14336
    ds_write_b32 v15, v105 offset:0
K2_m1_f1_flushed:
    s_mov_b32 s63, s70
    s_lshl_b32 s68, s70, 6
    v_pk_mul_f32 v[96:97], v[102:103], v[68:69]
    v_pk_mul_f32 v[98:99], v[102:103], v[36:37]
    s_branch K2_m1_g1
K2_m1_new2:
    v_add_u32 v15, s68, v2
    v_add_f32 v104, v96, v97
    v_add_f32 v105, v98, v99
    s_cmp_lg_u32 s39, 0
    s_cbranch_scc1 K2_m1_f2_atomic
    ds_write_b32 v15, v104 offset:14336
    ds_write_b32 v15, v105 offset:0
K2_m1_f2_flushed:
    s_mov_b32 s63, s70
    s_lshl_b32 s68, s70, 6
    v_pk_mul_f32 v[96:97], v[108:109], v[72:73]
    v_pk_mul_f32 v[98:99], v[108:109], v[40:41]
    s_branch K2_m1_g2
K2_m1_new3:
    v_add_u32 v15, s68, v2
    v_add_f32 v104, v96, v97
    v_add_f32 v105, v98, v99
    s_cmp_lg_u32 s39, 0
    s_cbranch_scc1 K2_m1_f3_atomic
    ds_write_b32 v15, v104 offset:14336
    ds_write_b32 v15, v105 offset:0
K2_m1_f3_flushed:
    s_mov_b32 s63, s70
    s_lshl_b32 s68, s70, 6
    v_pk_mul_f32 v[96:97], v[110:111], v[76:77]
    v_pk_mul_f32 v[98:99], v[110:111], v[44:45]
    s_branch K2_m1_g3
K2_m2_reload:
    s_mov_b32 s66, s65
    s_and_b32 s69, s65, 0xff
    s_mul_i32 s70, s69, 0x01010101
    s_cmp_eq_u32 s70, s65
    s_cbranch_scc0 K2_m2_mixed
    s_lshl_b32 s69, s69, 6
    v_add_u32 v15, s69, v106
    ds_read2_b32 v[90:91], v15 offset0:0 offset1:0
    s_branch K2_m2_loaded
K2_m2_mixed:
    s_bfe_u32 s69, s65, 0x80000
    s_lshl_b32 s69, s69, 6
    v_add_u32 v15, s69, v106
    ds_read_b32 v100, v15
    s_bfe_u32 s69, s65, 0x80008
    s_lshl_b32 s69, s69, 6
    v_add_u32 v15, s69, v106
    ds_read_b32 v101, v15
    s_bfe_u32 s69, s65, 0x80010
    s_lshl_b32 s69, s69, 6
    v_add_u32 v15, s69, v106
    ds_read_b32 v102, v15
    s_bfe_u32 s69, s65, 0x80018
    s_lshl_b32 s69, s69, 6
    v_add_u32 v15, s69, v106
    ds_read_b32 v103, v15
    s_mov_b32 s67, 1
    s_branch K2_m2_loaded
K2_m2_pack:
    s_waitcnt lgkmcnt(0)
    v_perm_b32 v90, v101, v100, s71
    v_perm_b32 v91, v103, v102, s71
    s_branch K2_m2_packed
K2_m2_slow:
    s_bfe_u32 s70, s64, 0x80000
    s_cmp_eq_u32 s70, s63
    s_cbranch_scc0 K2_m2_new0
    v_pk_fma_f32 v[96:97], v[100:101], v[64:65], v[96:97]
    v_pk_fma_f32 v[98:99], v[100:101], v[48:49], v[98:99]
K2_m2_g0:
    s_bfe_u32 s70, s64, 0x80008
    s_cmp_eq_u32 s70, s63
    s_cbranch_scc0 K2_m2_new1
    v_pk_fma_f32 v[96:97], v[102:103], v[68:69], v[96:97]
    v_pk_fma_f32 v[98:99], v[102:103], v[52:53], v[98:99]
K2_m2_g1:
    s_bfe_u32 s70, s64, 0x80010
    s_cmp_eq_u32 s70, s63
    s_cbranch_scc0 K2_m2_new2
    v_pk_fma_f32 v[96:97], v[108:109], v[72:73], v[96:97]
    v_pk_fma_f32 v[98:99], v[108:109], v[56:57], v[98:99]
K2_m2_g2:
    s_bfe_u32 s70, s64, 0x80018
    s_cmp_eq_u32 s70, s63
    s_cbranch_scc0 K2_m2_new3
    v_pk_fma_f32 v[96:97], v[110:111], v[76:77], v[96:97]
    v_pk_fma_f32 v[98:99], v[110:111], v[60:61], v[98:99]
K2_m2_g3:
    s_branch K2_m2_next
K2_m2_new0:
    v_add_u32 v15, s68, v2
    v_add_f32 v104, v96, v97
    v_add_f32 v105, v98, v99
    s_cmp_lg_u32 s39, 0
    s_cbranch_scc1 K2_m2_f0_atomic
    ds_write_b32 v15, v104 offset:14336
    ds_write_b32 v15, v105 offset:0
K2_m2_f0_flushed:
    s_mov_b32 s63, s70
    s_lshl_b32 s68, s70, 6
    v_pk_mul_f32 v[96:97], v[100:101], v[64:65]
    v_pk_mul_f32 v[98:99], v[100:101], v[48:49]
    s_branch K2_m2_g0
K2_m2_new1:
    v_add_u32 v15, s68, v2
    v_add_f32 v104, v96, v97
    v_add_f32 v105, v98, v99
    s_cmp_lg_u32 s39, 0
    s_cbranch_scc1 K2_m2_f1_atomic
    ds_write_b32 v15, v104 offset:14336
    ds_write_b32 v15, v105 offset:0
K2_m2_f1_flushed:
    s_mov_b32 s63, s70
    s_lshl_b32 s68, s70, 6
    v_pk_mul_f32 v[96:97], v[102:103], v[68:69]
    v_pk_mul_f32 v[98:99], v[102:103], v[52:53]
    s_branch K2_m2_g1
K2_m2_new2:
    v_add_u32 v15, s68, v2
    v_add_f32 v104, v96, v97
    v_add_f32 v105, v98, v99
    s_cmp_lg_u32 s39, 0
    s_cbranch_scc1 K2_m2_f2_atomic
    ds_write_b32 v15, v104 offset:14336
    ds_write_b32 v15, v105 offset:0
K2_m2_f2_flushed:
    s_mov_b32 s63, s70
    s_lshl_b32 s68, s70, 6
    v_pk_mul_f32 v[96:97], v[108:109], v[72:73]
    v_pk_mul_f32 v[98:99], v[108:109], v[56:57]
    s_branch K2_m2_g2
K2_m2_new3:
    v_add_u32 v15, s68, v2
    v_add_f32 v104, v96, v97
    v_add_f32 v105, v98, v99
    s_cmp_lg_u32 s39, 0
    s_cbranch_scc1 K2_m2_f3_atomic
    ds_write_b32 v15, v104 offset:14336
    ds_write_b32 v15, v105 offset:0
K2_m2_f3_flushed:
    s_mov_b32 s63, s70
    s_lshl_b32 s68, s70, 6
    v_pk_mul_f32 v[96:97], v[110:111], v[76:77]
    v_pk_mul_f32 v[98:99], v[110:111], v[60:61]
    s_branch K2_m2_g3
K2_t0_reload:
    s_mov_b32 s66, s65
    s_and_b32 s69, s65, 0xff
    s_mul_i32 s70, s69, 0x01010101
    s_cmp_eq_u32 s70, s65
    s_cbranch_scc0 K2_t0_mixed
    s_lshl_b32 s69, s69, 6
    v_add_u32 v15, s69, v106
    ds_read2_b32 v[90:91], v15 offset0:0 offset1:0
    s_branch K2_t0_loaded
K2_t0_mixed:
    s_bfe_u32 s69, s65, 0x80000
    s_lshl_b32 s69, s69, 6
    v_add_u32 v15, s69, v106
    ds_read_b32 v100, v15
    s_bfe_u32 s69, s65, 0x80008
    s_lshl_b32 s69, s69, 6
    v_add_u32 v15, s69, v106
    ds_read_b32 v101, v15
    s_bfe_u32 s69, s65, 0x80010
    s_lshl_b32 s69, s69, 6
    v_add_u32 v15, s69, v106
    ds_read_b32 v102, v15
    s_bfe_u32 s69, s65, 0x80018
    s_lshl_b32 s69, s69, 6
    v_add_u32 v15, s69, v106
    ds_read_b32 v103, v15
    s_mov_b32 s67, 1
    s_branch K2_t0_loaded
K2_t0_pack:
    s_waitcnt lgkmcnt(0)
    v_perm_b32 v90, v101, v100, s71
    v_perm_b32 v91, v103, v102, s71
    s_branch K2_t0_packed
K2_t0_slow:
    s_bfe_u32 s70, s64, 0x80000
    s_cmp_eq_u32 s70, s63
    s_cbranch_scc0 K2_t0_new0
    v_pk_fma_f32 v[96:97], v[100:101], v[64:65], v[96:97]
    v_pk_fma_f32 v[98:99], v[100:101], v[16:17], v[98:99]
K2_t0_g0:
    s_bfe_u32 s70, s64, 0x80008
    s_cmp_eq_u32 s70, s63
    s_cbranch_scc0 K2_t0_new1
    v_pk_fma_f32 v[96:97], v[102:103], v[68:69], v[96:97]
    v_pk_fma_f32 v[98:99], v[102:103], v[20:21], v[98:99]
K2_t0_g1:
    s_bfe_u32 s70, s64, 0x80010
    s_cmp_eq_u32 s70, s63
    s_cbranch_scc0 K2_t0_new2
    v_pk_fma_f32 v[96:97], v[108:109], v[72:73], v[96:97]
    v_pk_fma_f32 v[98:99], v[108:109], v[24:25], v[98:99]
K2_t0_g2:
    s_bfe_u32 s70, s64, 0x80018
    s_cmp_eq_u32 s70, s63
    s_cbranch_scc0 K2_t0_new3
    v_pk_fma_f32 v[96:97], v[110:111], v[76:77], v[96:97]
    v_pk_fma_f32 v[98:99], v[110:111], v[28:29], v[98:99]
K2_t0_g3:
    s_branch K2_t0_next
K2_t0_new0:
    v_add_u32 v15, s68, v2
    v_add_f32 v104, v96, v97
    v_add_f32 v105, v98, v99
    s_cmp_lg_u32 s39, 0
    s_cbranch_scc1 K2_t0_f0_atomic
    ds_write_b32 v15, v104 offset:14336
    ds_write_b32 v15, v105 offset:0
K2_t0_f0_flushed:
    s_mov_b32 s63, s70
    s_lshl_b32 s68, s70, 6
    v_pk_mul_f32 v[96:97], v[100:101], v[64:65]
    v_pk_mul_f32 v[98:99], v[100:101], v[16:17]
    s_branch K2_t0_g0
K2_t0_new1:
    v_add_u32 v15, s68, v2
    v_add_f32 v104, v96, v97
    v_add_f32 v105, v98, v99
    s_cmp_lg_u32 s39, 0
    s_cbranch_scc1 K2_t0_f1_atomic
    ds_write_b32 v15, v104 offset:14336
    ds_write_b32 v15, v105 offset:0
K2_t0_f1_flushed:
    s_mov_b32 s63, s70
    s_lshl_b32 s68, s70, 6
    v_pk_mul_f32 v[96:97], v[102:103], v[68:69]
    v_pk_mul_f32 v[98:99], v[102:103], v[20:21]
    s_branch K2_t0_g1
K2_t0_new2:
    v_add_u32 v15, s68, v2
    v_add_f32 v104, v96, v97
    v_add_f32 v105, v98, v99
    s_cmp_lg_u32 s39, 0
    s_cbranch_scc1 K2_t0_f2_atomic
    ds_write_b32 v15, v104 offset:14336
    ds_write_b32 v15, v105 offset:0
K2_t0_f2_flushed:
    s_mov_b32 s63, s70
    s_lshl_b32 s68, s70, 6
    v_pk_mul_f32 v[96:97], v[108:109], v[72:73]
    v_pk_mul_f32 v[98:99], v[108:109], v[24:25]
    s_branch K2_t0_g2
K2_t0_new3:
    v_add_u32 v15, s68, v2
    v_add_f32 v104, v96, v97
    v_add_f32 v105, v98, v99
    s_cmp_lg_u32 s39, 0
    s_cbranch_scc1 K2_t0_f3_atomic
    ds_write_b32 v15, v104 offset:14336
    ds_write_b32 v15, v105 offset:0
K2_t0_f3_flushed:
    s_mov_b32 s63, s70
    s_lshl_b32 s68, s70, 6
    v_pk_mul_f32 v[96:97], v[110:111], v[76:77]
    v_pk_mul_f32 v[98:99], v[110:111], v[28:29]
    s_branch K2_t0_g3
K2_t1_reload:
    s_mov_b32 s66, s65
    s_and_b32 s69, s65, 0xff
    s_mul_i32 s70, s69, 0x01010101
    s_cmp_eq_u32 s70, s65
    s_cbranch_scc0 K2_t1_mixed
    s_lshl_b32 s69, s69, 6
    v_add_u32 v15, s69, v106
    ds_read2_b32 v[90:91], v15 offset0:0 offset1:0
    s_branch K2_t1_loaded
K2_t1_mixed:
    s_bfe_u32 s69, s65, 0x80000
    s_lshl_b32 s69, s69, 6
    v_add_u32 v15, s69, v106
    ds_read_b32 v100, v15
    s_bfe_u32 s69, s65, 0x80008
    s_lshl_b32 s69, s69, 6
    v_add_u32 v15, s69, v106
    ds_read_b32 v101, v15
    s_bfe_u32 s69, s65, 0x80010
    s_lshl_b32 s69, s69, 6
    v_add_u32 v15, s69, v106
    ds_read_b32 v102, v15
    s_bfe_u32 s69, s65, 0x80018
    s_lshl_b32 s69, s69, 6
    v_add_u32 v15, s69, v106
    ds_read_b32 v103, v15
    s_mov_b32 s67, 1
    s_branch K2_t1_loaded
K2_t1_pack:
    s_waitcnt lgkmcnt(0)
    v_perm_b32 v90, v101, v100, s71
    v_perm_b32 v91, v103, v102, s71
    s_branch K2_t1_packed
K2_t1_slow:
    s_bfe_u32 s70, s64, 0x80000
    s_cmp_eq_u32 s70, s63
    s_cbranch_scc0 K2_t1_new0
    v_pk_fma_f32 v[96:97], v[100:101], v[64:65], v[96:97]
    v_pk_fma_f32 v[98:99], v[100:101], v[32:33], v[98:99]
K2_t1_g0:
    s_bfe_u32 s70, s64, 0x80008
    s_cmp_eq_u32 s70, s63
    s_cbranch_scc0 K2_t1_new1
    v_pk_fma_f32 v[96:97], v[102:103], v[68:69], v[96:97]
    v_pk_fma_f32 v[98:99], v[102:103], v[36:37], v[98:99]
K2_t1_g1:
    s_bfe_u32 s70, s64, 0x80010
    s_cmp_eq_u32 s70, s63
    s_cbranch_scc0 K2_t1_new2
    v_pk_fma_f32 v[96:97], v[108:109], v[72:73], v[96:97]
    v_pk_fma_f32 v[98:99], v[108:109], v[40:41], v[98:99]
K2_t1_g2:
    s_bfe_u32 s70, s64, 0x80018
    s_cmp_eq_u32 s70, s63
    s_cbranch_scc0 K2_t1_new3
    v_pk_fma_f32 v[96:97], v[110:111], v[76:77], v[96:97]
    v_pk_fma_f32 v[98:99], v[110:111], v[44:45], v[98:99]
K2_t1_g3:
    s_branch K2_t1_next
K2_t1_new0:
    v_add_u32 v15, s68, v2
    v_add_f32 v104, v96, v97
    v_add_f32 v105, v98, v99
    s_cmp_lg_u32 s39, 0
    s_cbranch_scc1 K2_t1_f0_atomic
    ds_write_b32 v15, v104 offset:14336
    ds_write_b32 v15, v105 offset:0
K2_t1_f0_flushed:
    s_mov_b32 s63, s70
    s_lshl_b32 s68, s70, 6
    v_pk_mul_f32 v[96:97], v[100:101], v[64:65]
    v_pk_mul_f32 v[98:99], v[100:101], v[32:33]
    s_branch K2_t1_g0
K2_t1_new1:
    v_add_u32 v15, s68, v2
    v_add_f32 v104, v96, v97
    v_add_f32 v105, v98, v99
    s_cmp_lg_u32 s39, 0
    s_cbranch_scc1 K2_t1_f1_atomic
    ds_write_b32 v15, v104 offset:14336
    ds_write_b32 v15, v105 offset:0
K2_t1_f1_flushed:
    s_mov_b32 s63, s70
    s_lshl_b32 s68, s70, 6
    v_pk_mul_f32 v[96:97], v[102:103], v[68:69]
    v_pk_mul_f32 v[98:99], v[102:103], v[36:37]
    s_branch K2_t1_g1
K2_t1_new2:
    v_add_u32 v15, s68, v2
    v_add_f32 v104, v96, v97
    v_add_f32 v105, v98, v99
    s_cmp_lg_u32 s39, 0
    s_cbranch_scc1 K2_t1_f2_atomic
    ds_write_b32 v15, v104 offset:14336
    ds_write_b32 v15, v105 offset:0
K2_t1_f2_flushed:
    s_mov_b32 s63, s70
    s_lshl_b32 s68, s70, 6
    v_pk_mul_f32 v[96:97], v[108:109], v[72:73]
    v_pk_mul_f32 v[98:99], v[108:109], v[40:41]
    s_branch K2_t1_g2
K2_t1_new3:
    v_add_u32 v15, s68, v2
    v_add_f32 v104, v96, v97
    v_add_f32 v105, v98, v99
    s_cmp_lg_u32 s39, 0
    s_cbranch_scc1 K2_t1_f3_atomic
    ds_write_b32 v15, v104 offset:14336
    ds_write_b32 v15, v105 offset:0
K2_t1_f3_flushed:
    s_mov_b32 s63, s70
    s_lshl_b32 s68, s70, 6
    v_pk_mul_f32 v[96:97], v[110:111], v[76:77]
    v_pk_mul_f32 v[98:99], v[110:111], v[44:45]
    s_branch K2_t1_g3
K2_t2_reload:
    s_mov_b32 s66, s65
    s_and_b32 s69, s65, 0xff
    s_mul_i32 s70, s69, 0x01010101
    s_cmp_eq_u32 s70, s65
    s_cbranch_scc0 K2_t2_mixed
    s_lshl_b32 s69, s69, 6
    v_add_u32 v15, s69, v106
    ds_read2_b32 v[90:91], v15 offset0:0 offset1:0
    s_branch K2_t2_loaded
K2_t2_mixed:
    s_bfe_u32 s69, s65, 0x80000
    s_lshl_b32 s69, s69, 6
    v_add_u32 v15, s69, v106
    ds_read_b32 v100, v15
    s_bfe_u32 s69, s65, 0x80008
    s_lshl_b32 s69, s69, 6
    v_add_u32 v15, s69, v106
    ds_read_b32 v101, v15
    s_bfe_u32 s69, s65, 0x80010
    s_lshl_b32 s69, s69, 6
    v_add_u32 v15, s69, v106
    ds_read_b32 v102, v15
    s_bfe_u32 s69, s65, 0x80018
    s_lshl_b32 s69, s69, 6
    v_add_u32 v15, s69, v106
    ds_read_b32 v103, v15
    s_mov_b32 s67, 1
    s_branch K2_t2_loaded
K2_t2_pack:
    s_waitcnt lgkmcnt(0)
    v_perm_b32 v90, v101, v100, s71
    v_perm_b32 v91, v103, v102, s71
    s_branch K2_t2_packed
K2_t2_slow:
    s_bfe_u32 s70, s64, 0x80000
    s_cmp_eq_u32 s70, s63
    s_cbranch_scc0 K2_t2_new0
    v_pk_fma_f32 v[96:97], v[100:101], v[64:65], v[96:97]
    v_pk_fma_f32 v[98:99], v[100:101], v[48:49], v[98:99]
K2_t2_g0:
    s_bfe_u32 s70, s64, 0x80008
    s_cmp_eq_u32 s70, s63
    s_cbranch_scc0 K2_t2_new1
    v_pk_fma_f32 v[96:97], v[102:103], v[68:69], v[96:97]
    v_pk_fma_f32 v[98:99], v[102:103], v[52:53], v[98:99]
K2_t2_g1:
    s_bfe_u32 s70, s64, 0x80010
    s_cmp_eq_u32 s70, s63
    s_cbranch_scc0 K2_t2_new2
    v_pk_fma_f32 v[96:97], v[108:109], v[72:73], v[96:97]
    v_pk_fma_f32 v[98:99], v[108:109], v[56:57], v[98:99]
K2_t2_g2:
    s_bfe_u32 s70, s64, 0x80018
    s_cmp_eq_u32 s70, s63
    s_cbranch_scc0 K2_t2_new3
    v_pk_fma_f32 v[96:97], v[110:111], v[76:77], v[96:97]
    v_pk_fma_f32 v[98:99], v[110:111], v[60:61], v[98:99]
K2_t2_g3:
    s_branch K2_t2_next
K2_t2_new0:
    v_add_u32 v15, s68, v2
    v_add_f32 v104, v96, v97
    v_add_f32 v105, v98, v99
    s_cmp_lg_u32 s39, 0
    s_cbranch_scc1 K2_t2_f0_atomic
    ds_write_b32 v15, v104 offset:14336
    ds_write_b32 v15, v105 offset:0
K2_t2_f0_flushed:
    s_mov_b32 s63, s70
    s_lshl_b32 s68, s70, 6
    v_pk_mul_f32 v[96:97], v[100:101], v[64:65]
    v_pk_mul_f32 v[98:99], v[100:101], v[48:49]
    s_branch K2_t2_g0
K2_t2_new1:
    v_add_u32 v15, s68, v2
    v_add_f32 v104, v96, v97
    v_add_f32 v105, v98, v99
    s_cmp_lg_u32 s39, 0
    s_cbranch_scc1 K2_t2_f1_atomic
    ds_write_b32 v15, v104 offset:14336
    ds_write_b32 v15, v105 offset:0
K2_t2_f1_flushed:
    s_mov_b32 s63, s70
    s_lshl_b32 s68, s70, 6
    v_pk_mul_f32 v[96:97], v[102:103], v[68:69]
    v_pk_mul_f32 v[98:99], v[102:103], v[52:53]
    s_branch K2_t2_g1
K2_t2_new2:
    v_add_u32 v15, s68, v2
    v_add_f32 v104, v96, v97
    v_add_f32 v105, v98, v99
    s_cmp_lg_u32 s39, 0
    s_cbranch_scc1 K2_t2_f2_atomic
    ds_write_b32 v15, v104 offset:14336
    ds_write_b32 v15, v105 offset:0
K2_t2_f2_flushed:
    s_mov_b32 s63, s70
    s_lshl_b32 s68, s70, 6
    v_pk_mul_f32 v[96:97], v[108:109], v[72:73]
    v_pk_mul_f32 v[98:99], v[108:109], v[56:57]
    s_branch K2_t2_g2
K2_t2_new3:
    v_add_u32 v15, s68, v2
    v_add_f32 v104, v96, v97
    v_add_f32 v105, v98, v99
    s_cmp_lg_u32 s39, 0
    s_cbranch_scc1 K2_t2_f3_atomic
    ds_write_b32 v15, v104 offset:14336
    ds_write_b32 v15, v105 offset:0
K2_t2_f3_flushed:
    s_mov_b32 s63, s70
    s_lshl_b32 s68, s70, 6
    v_pk_mul_f32 v[96:97], v[110:111], v[76:77]
    v_pk_mul_f32 v[98:99], v[110:111], v[60:61]
    s_branch K2_t2_g3
K2_m0_f0_atomic:
    ds_add_f32 v15, v104 offset:14336
    ds_add_f32 v15, v105 offset:0
    s_branch K2_m0_f0_flushed
K2_m0_f1_atomic:
    ds_add_f32 v15, v104 offset:14336
    ds_add_f32 v15, v105 offset:0
    s_branch K2_m0_f1_flushed
K2_m0_f2_atomic:
    ds_add_f32 v15, v104 offset:14336
    ds_add_f32 v15, v105 offset:0
    s_branch K2_m0_f2_flushed
K2_m0_f3_atomic:
    ds_add_f32 v15, v104 offset:14336
    ds_add_f32 v15, v105 offset:0
    s_branch K2_m0_f3_flushed
K2_m1_f0_atomic:
    ds_add_f32 v15, v104 offset:14336
    ds_add_f32 v15, v105 offset:0
    s_branch K2_m1_f0_flushed
K2_m1_f1_atomic:
    ds_add_f32 v15, v104 offset:14336
    ds_add_f32 v15, v105 offset:0
    s_branch K2_m1_f1_flushed
K2_m1_f2_atomic:
    ds_add_f32 v15, v104 offset:14336
    ds_add_f32 v15, v105 offset:0
    s_branch K2_m1_f2_flushed
K2_m1_f3_atomic:
    ds_add_f32 v15, v104 offset:14336
    ds_add_f32 v15, v105 offset:0
    s_branch K2_m1_f3_flushed
K2_m2_f0_atomic:
    ds_add_f32 v15, v104 offset:14336
    ds_add_f32 v15, v105 offset:0
    s_branch K2_m2_f0_flushed
K2_m2_f1_atomic:
    ds_add_f32 v15, v104 offset:14336
    ds_add_f32 v15, v105 offset:0
    s_branch K2_m2_f1_flushed
K2_m2_f2_atomic:
    ds_add_f32 v15, v104 offset:14336
    ds_add_f32 v15, v105 offset:0
    s_branch K2_m2_f2_flushed
K2_m2_f3_atomic:
    ds_add_f32 v15, v104 offset:14336
    ds_add_f32 v15, v105 offset:0
    s_branch K2_m2_f3_flushed
K2_t0_f0_atomic:
    ds_add_f32 v15, v104 offset:14336
    ds_add_f32 v15, v105 offset:0
    s_branch K2_t0_f0_flushed
K2_t0_f1_atomic:
    ds_add_f32 v15, v104 offset:14336
    ds_add_f32 v15, v105 offset:0
    s_branch K2_t0_f1_flushed
K2_t0_f2_atomic:
    ds_add_f32 v15, v104 offset:14336
    ds_add_f32 v15, v105 offset:0
    s_branch K2_t0_f2_flushed
K2_t0_f3_atomic:
    ds_add_f32 v15, v104 offset:14336
    ds_add_f32 v15, v105 offset:0
    s_branch K2_t0_f3_flushed
K2_t1_f0_atomic:
    ds_add_f32 v15, v104 offset:14336
    ds_add_f32 v15, v105 offset:0
    s_branch K2_t1_f0_flushed
K2_t1_f1_atomic:
    ds_add_f32 v15, v104 offset:14336
    ds_add_f32 v15, v105 offset:0
    s_branch K2_t1_f1_flushed
K2_t1_f2_atomic:
    ds_add_f32 v15, v104 offset:14336
    ds_add_f32 v15, v105 offset:0
    s_branch K2_t1_f2_flushed
K2_t1_f3_atomic:
    ds_add_f32 v15, v104 offset:14336
    ds_add_f32 v15, v105 offset:0
    s_branch K2_t1_f3_flushed
K2_t2_f0_atomic:
    ds_add_f32 v15, v104 offset:14336
    ds_add_f32 v15, v105 offset:0
    s_branch K2_t2_f0_flushed
K2_t2_f1_atomic:
    ds_add_f32 v15, v104 offset:14336
    ds_add_f32 v15, v105 offset:0
    s_branch K2_t2_f1_flushed
K2_t2_f2_atomic:
    ds_add_f32 v15, v104 offset:14336
    ds_add_f32 v15, v105 offset:0
    s_branch K2_t2_f2_flushed
K2_t2_f3_atomic:
    ds_add_f32 v15, v104 offset:14336
    ds_add_f32 v15, v105 offset:0
    s_branch K2_t2_f3_flushed
K2_range_end:
    v_add_u32 v15, s68, v2
    v_add_f32 v104, v96, v97
    v_add_f32 v105, v98, v99
    s_cmp_lg_u32 s39, 0
    s_cbranch_scc1 K2_last_atomic
    ds_write_b32 v15, v104 offset:14336
    ds_write_b32 v15, v105 offset:0
K2_last_flushed:
    s_branch K2_main_done
K2_empty_range:
    s_cmp_lg_u32 s39, 0
    s_cbranch_scc1 K2_main_done
    s_cmp_lg_u32 s39, 0
    s_cbranch_scc1 K2_xl2
    s_mul_i32 s41, s37, 5120
    v_lshl_add_u32 v15, v0, 3, s41
    v_min_u32 v15, 1279992, v15
    global_load_dwordx2 v[12:13], v15, s[4:5]
K2_xl2:
    s_lshl_b32 s69, s76, 2
    v_mov_b32 v15, s69
    v_mov_b32 v104, 0xff
    ds_write_b32 v15, v104 offset:28944
K2_main_done:
    s_setprio 0
    s_add_u32 s39, s39, 32
    s_cmp_ge_u32 s39, s40
    s_cbranch_scc1 K2_final
    s_cmp_lg_u32 s38, 0
    s_cbranch_scc1 K2_nozc
    v_mov_b32 v76, 0
    ds_write_b32 v2, v76 offset:28672
K2_nozc:
    v_cmp_ne_u32 vcc, 0, v5
    v_mov_b32 v76, 0x80
    s_nop 0
    v_cndmask_b32 v5, 0, v76, vcc
    v_lshrrev_b32 v78, 4, v1
    s_lshl_b32 s69, s38, 2
    v_add_u32 v78, s69, v78
    v_mul_u32_u24 v78, 10240, v78
    v_and_b32 v76, 15, v1
    v_add_u32 v76, s39, v76
    v_add_u32 v78, v78, v76
    v_mul_u32_u24 v100, 12, v78
    v_add_u32 v101, 30720, v100
    v_add_u32 v102, 30720, v101
    v_add_u32 v103, 30720, v102
    v_add_u32 v77, 17, v76
    v_lshlrev_b32 v77, 16, v77
    s_waitcnt lgkmcnt(0)
    s_barrier
    s_branch K2_pass
K2_final:
    s_waitcnt vmcnt(0) lgkmcnt(0)
    s_barrier
    s_cmp_ge_u32 s38, 10
    s_cbranch_scc1 K2_end
    v_lshlrev_b32 v67, 4, v0
    ds_read_b128 v[16:19], v67 offset:0
    ds_read_b128 v[20:23], v67 offset:14336
    ds_read_b128 v[24:27], v67 offset:29696
    v_and_b32 v30, 15, v1
    v_lshlrev_b32 v31, 2, v30
    ds_read_b32 v31, v31 offset:28944
    s_mul_i32 s41, s37, 5120
    v_lshl_add_u32 v66, v0, 3, s41
    s_mov_b32 s42, 0x550637bd
    v_lshrrev_b32 v32, 4, v0
    v_lshlrev_b32 v32, 2, v32
    v_lshlrev_b32 v33, 4, v30
    s_waitcnt lgkmcnt(0)
    v_lshrrev_b32 v34, 4, v31
    v_cmp_eq_u32 vcc, s38, v34
    s_and_b32 s44, vcc_lo, 0xffff
K2_merge:
    s_cmp_eq_u32 s44, 0
    s_cbranch_scc1 K2_merged
    s_ff1_i32_b32 s45, s44
    s_bitset0_b32 s44, s45
    v_readlane_b32 s46, v31, s45
    s_add_u32 s45, s45, 40
    s_lshl_b32 s45, s45, 8
    v_add_u32 v35, s45, v33
    ds_read_b128 v[36:39], v35 offset:0
    ds_read_b128 v[40:43], v35 offset:14336
    v_cmp_eq_u32 vcc, s46, v32
    s_waitcnt lgkmcnt(0)
    s_mov_b64 exec, vcc
    v_add_f32 v16, v16, v36
    v_add_f32 v20, v20, v40
    v_add_f32 v17, v17, v37
    v_add_f32 v21, v21, v41
    v_add_f32 v18, v18, v38
    v_add_f32 v22, v22, v42
    v_add_f32 v19, v19, v39
    v_add_f32 v23, v23, v43
    s_mov_b64 exec, -1
    s_branch K2_merge
K2_merged:
    v_add_f32 v20, s42, v20
    v_add_f32 v21, s42, v21
    v_add_f32 v22, s42, v22
    v_add_f32 v23, s42, v23
    v_rcp_f32 v20, v20
    v_rcp_f32 v21, v21
    v_rcp_f32 v22, v22
    v_rcp_f32 v23, v23
    v_and_b32 v24, 0xffff0000, v24
    v_and_b32 v25, 0xffff0000, v25
    v_and_b32 v26, 0xffff0000, v26
    v_and_b32 v27, 0xffff0000, v27
    v_fma_f32 v16, v16, v20, v24
    v_fma_f32 v17, v17, v21, v25
    v_fma_f32 v18, v18, v22, v26
    v_fma_f32 v19, v19, v23, v27
    v_mul_f32 v20, 0, v16
    v_mul_f32 v21, 0, v17
    v_mul_f32 v22, 0, v18
    v_mul_f32 v23, 0, v19
    v_cmp_lt_f32 vcc, 0, v16
    s_nop 1
    v_cndmask_b32 v16, v20, v16, vcc
    v_cmp_lt_f32 vcc, 0, v17
    s_nop 1
    v_cndmask_b32 v17, v21, v17, vcc
    v_cmp_lt_f32 vcc, 0, v18
    s_nop 1
    v_cndmask_b32 v18, v22, v18, vcc
    v_cmp_lt_f32 vcc, 0, v19
    s_nop 1
    v_cndmask_b32 v19, v23, v19, vcc
    v_lshlrev_b32 v24, 16, v12
    v_and_b32 v25, 0xffff0000, v12
    v_lshlrev_b32 v26, 16, v13
    v_and_b32 v27, 0xffff0000, v13
    v_add_f32 v16, v16, v24
    v_add_f32 v17, v17, v25
    v_add_f32 v18, v18, v26
    v_add_f32 v19, v19, v27
    v_cvt_pk_bf16_f32 v28, v16, v17
    v_cvt_pk_bf16_f32 v29, v18, v19
    global_store_dwordx2 v66, v[28:29], s[22:23] sc1
K2_end:
K2_done:
    s_endpgm
K2_idle:
    v_readfirstlane_b32 s38, v0
    s_waitcnt lgkmcnt(0)
    s_lshr_b32 s38, s38, 6
    s_lshr_b32 s41, s2, 3
    s_mul_i32 s41, s41, 81920
    v_lshl_add_u32 v109, v0, 6, s41
    global_load_dword v108, v109, s[26:27]
    v_add_u32 v109, 0x4000, v109
    global_load_dword v108, v109, s[26:27]
    s_endpgm
K2_last_atomic:
    ds_add_f32 v15, v104 offset:14336
    ds_add_f32 v15, v105 offset:0
    s_branch K2_last_flushed
.section .rodata,"a"
.p2align 6
.amdhsa_kernel gcn_prep_kernel
  .amdhsa_next_free_vgpr 80
  .amdhsa_next_free_sgpr 56
  .amdhsa_accum_offset 80
  .amdhsa_group_segment_fixed_size 0
  .amdhsa_kernarg_size 96
  .amdhsa_user_sgpr_count 2
  .amdhsa_user_sgpr_kernarg_segment_ptr 1
  .amdhsa_system_sgpr_workgroup_id_x 1
.end_amdhsa_kernel
.p2align 6
.amdhsa_kernel standalone__edge_featured_mpnn_gatedgcn__graph_kernel
  .amdhsa_next_free_vgpr 128
  .amdhsa_next_free_sgpr 80
  .amdhsa_accum_offset 128
  .amdhsa_group_segment_fixed_size 0
  .amdhsa_kernarg_size 96
  .amdhsa_user_sgpr_count 2
  .amdhsa_user_sgpr_kernarg_segment_ptr 1
  .amdhsa_system_sgpr_workgroup_id_x 1
.end_amdhsa_kernel
```
